```python
import torch

def _softmax(x, axis=-1):
    return torch.softmax(x, dim=axis)
def _gelu(x):
    return torch.nn.functional.gelu(x, approximate="tanh")
def _silu(x):
    return torch.nn.functional.silu(x)
def _sigmoid(x):
    return torch.sigmoid(x)
def _layernorm(x, axis=-1, eps=1e-5):
    m = x.mean(dim=axis, keepdim=True)
    v = x.var(dim=axis, keepdim=True, unbiased=False)
    return (x - m) / torch.sqrt(v + eps)
def _scatter_add(tgt, idx, src, axis=0):
    return tgt.clone().index_add_(axis, idx, src)
def _segment_sum(src, seg, n):
    out = torch.zeros((n,) + src.shape[1:], dtype=src.dtype)
    return out.index_add_(0, seg, src)
def _pad(x, pw):
    flat = tuple(v for pair in reversed(pw) for v in pair)
    return torch.nn.functional.pad(x, flat)

kernel_name = 'sequential_preLN__linear_attn_block__glu_gated_bilinear__prompt'

def setup_inputs():

    _w = (lambda a: (lambda t: t.to(torch.bfloat16) if t.is_floating_point() else t)(torch.as_tensor(a)))
    def _A_setup():
        B, S, D = 1, 2048, 448
        return {
            "x": _w((lambda *s: torch.randn(*s, dtype=torch.bfloat16) * 0.05)(B, S, D)),
            "wqkv": _w((lambda *s: torch.randn(*s, dtype=torch.bfloat16) * 0.1)(D, 3 * D)),
            "wo": _w((lambda *s: torch.randn(*s, dtype=torch.bfloat16) * 0.05)(D, D)),
        }
    _A_in = _A_setup()

    def _B_setup():
        B, S, D, F = 1, 2048, 448, 1792
        return {
            "x": _w((lambda *s: torch.randn(*s, dtype=torch.bfloat16) * 0.05)(B, S, D)),
            "w_gate": _w((lambda *s: torch.randn(*s, dtype=torch.bfloat16) * 0.4)(D, F) * (D ** -0.5)),
            "w_up": _w((lambda *s: torch.randn(*s, dtype=torch.bfloat16) * 0.4)(D, F) * (D ** -0.5)),
            "w_down": _w((lambda *s: torch.randn(*s, dtype=torch.bfloat16) * 0.4)(F, D) * (F ** -0.5)),
        }
    _B_in = _B_setup()

    return {
        "A_x": _A_in["x"],
        "A_wqkv": _A_in["wqkv"],
        "A_wo": _A_in["wo"],
        "B_x": _B_in["x"],
        "B_w_gate": _B_in["w_gate"],
        "B_w_up": _B_in["w_up"],
        "B_w_down": _B_in["w_down"],
    }

def reference(A_x, A_wqkv, A_wo, B_x, B_w_gate, B_w_up, B_w_down):
    def _A_ref(x, wqkv, wo):
        B, S, D = x.shape
        H = 16; Dh = D // H
        qkv = (lambda x, *d: x.permute(*d))((x @ wqkv).reshape(B, S, 3, H, Dh), 2, 0, 3, 1, 4)
        q, k, v = qkv[0], qkv[1], qkv[2]
        phi = lambda t: torch.where(t > 0, t + 1, torch.exp(t)) + 1e-6
        pq, pk = phi(q), phi(k)
        kv = torch.einsum("bhsd,bhse->bhde", pk, v)
        z = torch.einsum("bhsd->bhd", pk)
        num = torch.einsum("bhqd,bhde->bhqe", pq, kv)
        den = torch.einsum("bhqd,bhd->bhq", pq, z)[..., None] + 1e-6
        o = num / den
        return (lambda x, *d: x.permute(*d))(o, 0, 2, 1, 3).reshape(B, S, D) @ wo

    def _B_ref(x, w_gate, w_up, w_down):
        g = torch.einsum("bsd,df->bsf", x, w_gate)
        u = torch.einsum("bsd,df->bsf", x, w_up)
        h = g * u
        return torch.einsum("bsf,fd->bsd", h, w_down)

    x = A_x
    h = x + _A_ref(_layernorm(x, axis=-1), A_wqkv, A_wo)
    h2 = h + _B_ref(_layernorm(h, axis=-1), B_w_gate, B_w_up, B_w_down)
    return h2
```

```asm
; @launch grid=(256,1,1) block=(256,1,1) lds=163840
.amdgcn_target "amdgcn-amd-amdhsa--gfx950"
.text
.p2align 12
.fill 832, 4, 0xbf800000
.globl sequential_preLN__linear_attn_block__glu_gated_bilinear__prompt_kernel
.p2align 8
.type sequential_preLN__linear_attn_block__glu_gated_bilinear__prompt_kernel,@function
sequential_preLN__linear_attn_block__glu_gated_bilinear__prompt_kernel:
  s_cmp_ge_u32 s2, 256
  s_cbranch_scc1 L_end
  s_load_dwordx2 s[4:5], s[0:1], 0
  s_load_dwordx2 s[8:9], s[0:1], 8
  s_load_dwordx2 s[12:13], s[0:1], 72
  s_load_dwordx2 s[20:21], s[0:1], 16
  s_load_dwordx2 s[24:25], s[0:1], 32
  s_load_dwordx2 s[28:29], s[0:1], 40
  s_load_dwordx2 s[32:33], s[0:1], 48
  s_load_dwordx2 s[36:37], s[0:1], 56
  v_and_b32 v1, 63, v0
  v_lshrrev_b32 v3, 6, v0
  s_nop 0
  v_readfirstlane_b32 s40, v3
  s_and_b32 s3, s2, 7
  s_lshr_b32 s47, s2, 3
  s_and_b32 s48, s47, 7
  s_lshr_b32 s49, s47, 3
  s_and_b32 s41, s3, 3
  s_lshl_b32 s41, s41, 3
  s_add_u32 s41, s41, s48
  s_and_b32 s42, s3, 4
  s_add_u32 s42, s42, s49
  s_lshl_b32 s49, s49, 1
  s_add_u32 s48, s48, s49
  s_sub_u32 s49, s48, 7
  s_cselect_b32 s48, s48, s49
  v_lshrrev_b32 v4, 3, v1
  v_and_b32 v6, 7, v1
  v_bfe_u32 v5, v1, 4, 1
  v_lshlrev_b32 v5, 2, v5
  v_xor_b32 v7, v5, v6
  v_min_u32 v5, 6, v7
  v_mul_u32_u24 v10, 2688, v4
  v_lshl_add_u32 v10, v5, 4, v10
  v_add_u32 v11, 20480, v10
  v_mul_u32_u24 v12, 896, v4
  v_xor_b32 v6, v6, v4
  v_lshl_add_u32 v8, v6, 4, v12
  v_xor_b32 v9, 16, v8
  v_add_u32 v9, 6144, v9
  v_lshl_add_u32 v12, v7, 4, v12
  s_lshl_b32 s56, s41, 2
  s_add_u32 s56, s56, s40
  s_mul_i32 s56, s56, 14336
  s_add_u32 s57, s56, 896
  s_lshl_b32 s55, s48, 7
  s_add_u32 s55, s55, s56
  s_mul_i32 s101, s40, 43008
  s_mul_i32 s58, s42, 112
  s_add_u32 s101, s101, s58
  s_mul_i32 s100, s48, 172032
  s_add_u32 s100, s100, s101
  s_lshl_b32 s52, s40, 11
  s_mov_b32 s6, 1835008
  s_mov_b32 s7, 0x00020000
  s_mov_b32 s10, 1204224
  s_mov_b32 s11, 0x00020000
  s_mov_b32 s16, s100
  s_add_u32 s17, s101, 1204224
  s_waitcnt lgkmcnt(0)
  s_add_u32 m0, s52, 31872
  s_nop 0
  buffer_load_dwordx4 v10, s[8:11], s100 offen offset:896 lds
  buffer_load_dwordx4 v11, s[8:11], s100 offen offset:1920 lds
  s_add_u32 m0, s52, 39168
  s_nop 0
  buffer_load_dwordx4 v10, s[8:11], s100 offen offset:1792 lds
  buffer_load_dwordx4 v11, s[8:11], s100 offen offset:2816 lds
  s_add_u32 m0, s52, 24576
  s_nop 0
  buffer_load_dwordx4 v8, s[4:7], s55 offen lds
  buffer_load_dwordx4 v9, s[4:7], s55 offen offset:1024 lds
  s_add_u32 s55, s55, 128
  s_add_u32 s100, s100, 172032
  s_cmp_eq_u32 s55, s57
  s_cselect_b32 s55, s56, s55
  s_cselect_b32 s100, s101, s100
  s_mov_b32 s14, 268435456
  s_mov_b32 s15, 0x00020000
  s_load_dword s1, s[12:13], 0
  v_mov_b32 v96, 0
  v_mov_b32 v97, 0
  v_mov_b32 v98, 0
  v_mov_b32 v99, 0
  v_lshlrev_b32 v2, 4, v1
  s_lshl_b32 s58, s2, 7
  s_add_u32 s58, s58, 1048576
  s_lshl_b32 s59, s40, 5
  s_add_u32 s58, s58, s59
  s_mov_b64 exec, 3
  buffer_store_dwordx4 v[96:99], v2, s[12:15], s58 offen sc1
  s_mov_b64 exec, -1
  s_cmp_eq_u32 s40, 0
  s_cbranch_scc1 L_pg1
  s_cmp_eq_u32 s40, 1
  s_cbranch_scc1 L_pg2
  s_cmp_eq_u32 s40, 2
  s_cbranch_scc1 L_pg3
  s_cmp_eq_u32 s40, 3
  s_cbranch_scc1 L_pg4
L_bk1:
  s_add_u32 m0, s52, 56448
  s_nop 0
  buffer_load_dwordx4 v10, s[8:11], s100 offen offset:896 lds
  buffer_load_dwordx4 v11, s[8:11], s100 offen offset:1920 lds
  s_add_u32 m0, s52, 63744
  s_nop 0
  buffer_load_dwordx4 v10, s[8:11], s100 offen offset:1792 lds
  buffer_load_dwordx4 v11, s[8:11], s100 offen offset:2816 lds
  s_add_u32 m0, s52, 49152
  s_nop 0
  buffer_load_dwordx4 v8, s[4:7], s55 offen lds
  buffer_load_dwordx4 v9, s[4:7], s55 offen offset:1024 lds
  s_add_u32 s55, s55, 128
  s_add_u32 s100, s100, 172032
  s_cmp_eq_u32 s55, s57
  s_cselect_b32 s55, s56, s55
  s_cselect_b32 s100, s101, s100
  s_and_b32 s48, s47, 3
  s_lshr_b32 s49, s47, 2
  s_lshl_b32 s43, s3, 2
  s_add_u32 s43, s43, s48
  s_min_u32 s44, s49, 6
  s_and_b32 s45, s3, 1
  s_lshl_b32 s45, s45, 2
  s_add_u32 s45, s45, s48
  s_lshr_b32 s46, s3, 1
  s_mul_i32 s46, s46, 7
  s_add_u32 s46, s46, s44
  s_mov_b32 s22, 401408
  s_mov_b32 s23, 0x00020000
  s_mov_b32 s26, 1605632
  s_mov_b32 s27, 0x00020000
  s_mov_b32 s30, 1605632
  s_mov_b32 s31, 0x00020000
  s_mov_b32 s34, 1605632
  s_mov_b32 s35, 0x00020000
  s_mov_b32 s38, 1835008
  s_mov_b32 s39, 0x00020000
  s_lshl_b32 s0, s48, 1
  s_add_u32 s0, s0, s44
  s_add_u32 s0, s0, s3
  s_sub_u32 s48, s0, 7
  s_cselect_b32 s0, s0, s48
  s_sub_u32 s48, s0, 7
  s_cselect_b32 s0, s0, s48
  s_and_b32 s58, s40, 1
  s_mul_i32 s58, s58, 56
  s_lshr_b32 s59, s40, 1
  v_and_b32 v6, 3, v1
  v_lshl_add_u32 v5, v6, 3, s58
  v_bfe_u32 v6, v1, 4, 1
  v_lshl_add_u32 v26, v6, 5, v5
  v_xor_b32 v6, s59, v6
  v_lshl_add_u32 v24, v6, 5, v5
  v_bfe_u32 v6, v1, 3, 1
  v_lshlrev_b32 v6, 6, v6
  v_xor_b32 v26, v26, v6
  v_xor_b32 v24, v24, v6
  v_lshrrev_b32 v3, 5, v1
  v_bfe_u32 v5, v1, 2, 2
  v_lshl_add_u32 v5, v3, 3, v5
  v_lshl_add_u32 v26, v5, 7, v26
  v_lshl_add_u32 v24, v5, 7, v24
  v_add_u32 v116, 106496, v26
  v_add_u32 v27, 49152, v26
  v_add_u32 v25, 49152, v24
  v_and_b32 v6, 31, v1
  s_lshl_b32 s59, s59, 12
  v_lshl_add_u32 v7, v6, 7, s59
  v_bfe_u32 v6, v1, 3, 1
  v_xor_b32 v6, v6, v3
  v_and_b32 v5, 7, v1
  v_xor_b32 v6, v6, v5
  v_lshl_add_u32 v16, v6, 4, v7
  v_xor_b32 v17, 32, v16
  v_xor_b32 v18, 64, v16
  v_xor_b32 v19, 96, v16
  v_add_u32 v20, 49152, v16
  v_add_u32 v21, 49152, v17
  v_add_u32 v22, 49152, v18
  v_add_u32 v23, 49152, v19
  s_mov_b32 vcc_lo, 0xf0f00f0f
  s_mov_b32 vcc_hi, 0xf0f00f0f
  v_mov_b32 v4, 1065369472
  v_cndmask_b32 v112, v96, v4
  v_cndmask_b32 v113, v96, v4
  v_cndmask_b32 v114, v96, v4
  v_cndmask_b32 v115, v96, v4
  s_cmp_eq_u32 s40, 0
  s_cbranch_scc1 L_pg5
  s_cmp_eq_u32 s40, 1
  s_cbranch_scc1 L_pg6
  s_cmp_eq_u32 s40, 2
  s_nop 0
  s_cmp_eq_u32 s40, 3
  s_nop 0
L_bk2:
  s_add_u32 m0, s52, 81024
  s_nop 0
  buffer_load_dwordx4 v10, s[8:11], s100 offen offset:896 lds
  buffer_load_dwordx4 v11, s[8:11], s100 offen offset:1920 lds
  s_add_u32 m0, s52, 88320
  s_nop 0
  buffer_load_dwordx4 v10, s[8:11], s100 offen offset:1792 lds
  buffer_load_dwordx4 v11, s[8:11], s100 offen offset:2816 lds
  s_add_u32 m0, s52, 73728
  s_nop 0
  buffer_load_dwordx4 v8, s[4:7], s55 offen lds
  buffer_load_dwordx4 v9, s[4:7], s55 offen offset:1024 lds
  s_add_u32 s55, s55, 128
  s_add_u32 s100, s100, 172032
  s_cmp_eq_u32 s55, s57
  s_cselect_b32 s55, s56, s55
  s_cselect_b32 s100, s101, s100
  v_lshrrev_b32 v4, 3, v1
  v_mul_u32_u24 v122, 3584, v4
  v_bfe_u32 v4, v1, 4, 1
  v_lshlrev_b32 v4, 1, v4
  v_and_b32 v5, 7, v1
  v_xor_b32 v4, v4, v5
  v_xor_b32 v5, 4, v4
  v_lshl_add_u32 v124, v5, 4, v122
  v_lshl_add_u32 v122, v4, 4, v122
  v_add_u32 v125, 27648, v124
  v_add_u32 v123, 27648, v122
  s_mul_i32 s53, s40, 57344
  s_lshl_b32 s54, s46, 7
  s_add_u32 s53, s53, s54
  s_add_u32 s54, s53, 1605632
  s_mul_i32 s50, s0, 229376
  s_add_u32 s50, s50, s53
  s_mov_b32 s51, s50
  s_mul_i32 s18, s40, 100352
  s_lshl_b32 s48, s44, 7
  s_add_u32 s18, s18, s48
  s_lshl_b32 s19, s40, 10
  v_bfe_u32 v4, v1, 3, 2
  s_lshl_b32 s58, s40, 2
  v_add_u32 v4, s58, v4
  v_min_u32 v4, 13, v4
  s_mul_i32 s58, s47, 14
  v_add_u32 v4, s58, v4
  v_and_b32 v5, 7, v1
  v_lshlrev_b32 v5, 7, v5
  v_lshrrev_b32 v6, 5, v1
  v_lshl_add_u32 v5, v6, 6, v5
  v_mul_u32_u24 v4, 896, v4
  v_add_u32 v31, v4, v5
  s_lshr_b32 s58, s3, 2
  s_mul_i32 s58, s58, 384
  v_lshl_add_u32 v29, v4, 1, v31
  v_add_u32 v29, s58, v29
  s_lshr_b32 s58, s3, 1
  s_mul_i32 s58, s58, 896
  v_add_u32 v5, s58, v5
  v_lshl_add_u32 v30, v4, 2, v5
  s_waitcnt vmcnt(13) lgkmcnt(0)
  s_barrier
  s_add_u32 s1, s1, 0x01010101
  ds_read_b128 a[128:131], v16 offset:24576
  ds_read_b64_tr_b16 v[128:129], v24 offset:32768
  ds_read_b64_tr_b16 v[130:131], v24 offset:33280
  ds_read_b64_tr_b16 v[132:133], v26 offset:40960
  ds_read_b64_tr_b16 v[134:135], v26 offset:41472
  ds_read_b128 a[132:135], v17 offset:24576
  ds_read_b64_tr_b16 v[136:137], v24 offset:34816
  ds_read_b64_tr_b16 v[138:139], v24 offset:35328
  ds_read_b64_tr_b16 v[140:141], v26 offset:43008
  ds_read_b64_tr_b16 v[142:143], v26 offset:43520
  s_add_u32 m0, s52, 7296
  s_nop 0
  buffer_load_dwordx4 v10, s[8:11], s100 offen offset:896 lds
  buffer_load_dwordx4 v11, s[8:11], s100 offen offset:1920 lds
  s_waitcnt lgkmcnt(9)
  v_mfma_f32_32x32x16_bf16 v[64:79], a[128:131], a[128:131], 0
  ds_read_b128 a[136:139], v18 offset:24576
  v_mfma_f32_16x16x32_bf16 v[104:107], v[112:115], a[128:131], 0
  ds_read_b64_tr_b16 v[144:145], v24 offset:36864
  s_add_u32 m0, s52, 14592
  s_nop 0
  buffer_load_dwordx4 v10, s[8:11], s100 offen offset:1792 lds
  s_waitcnt lgkmcnt(9)
  v_mfma_f32_32x32x16_bf16 v[32:47], a[128:131], v[128:131], 0
  ds_read_b64_tr_b16 v[146:147], v24 offset:37376
  v_mfma_f32_16x16x32_bf16 v[96:99], v[112:115], v[128:131], 0
  ds_read_b64_tr_b16 v[148:149], v26 offset:45056
  s_waitcnt lgkmcnt(9)
  v_mfma_f32_32x32x16_bf16 v[48:63], a[128:131], v[132:135], 0
  ds_read_b64_tr_b16 v[150:151], v26 offset:45568
  buffer_load_dwordx4 v11, s[8:11], s100 offen offset:2816 lds
  v_mfma_f32_16x16x32_bf16 v[100:103], v[112:115], v[132:135], 0
  s_waitcnt lgkmcnt(9)
  v_mfma_f32_32x32x16_bf16 v[64:79], a[132:135], a[132:135], v[64:79]
  ds_read_b128 a[140:143], v19 offset:24576
  v_mfma_f32_16x16x32_bf16 v[104:107], v[112:115], a[132:135], v[104:107]
  ds_read_b64_tr_b16 v[152:153], v24 offset:38912
  s_waitcnt lgkmcnt(9)
  v_mfma_f32_32x32x16_bf16 v[32:47], a[132:135], v[136:139], v[32:47]
  ds_read_b64_tr_b16 v[154:155], v24 offset:39424
  v_mfma_f32_16x16x32_bf16 v[96:99], v[112:115], v[136:139], v[96:99]
  ds_read_b64_tr_b16 v[156:157], v26 offset:47104
  s_add_u32 m0, s52, 0
  s_nop 0
  buffer_load_dwordx4 v8, s[4:7], s55 offen lds
  s_waitcnt lgkmcnt(9)
  v_mfma_f32_32x32x16_bf16 v[48:63], a[132:135], v[140:143], v[48:63]
  ds_read_b64_tr_b16 v[158:159], v26 offset:47616
  v_mfma_f32_16x16x32_bf16 v[100:103], v[112:115], v[140:143], v[100:103]
  s_waitcnt lgkmcnt(9)
  v_mfma_f32_32x32x16_bf16 v[64:79], a[136:139], a[136:139], v[64:79]
  v_mfma_f32_16x16x32_bf16 v[104:107], v[112:115], a[136:139], v[104:107]
  s_waitcnt lgkmcnt(7)
  v_mfma_f32_32x32x16_bf16 v[32:47], a[136:139], v[144:147], v[32:47]
  v_mfma_f32_16x16x32_bf16 v[96:99], v[112:115], v[144:147], v[96:99]
  buffer_load_dwordx4 v9, s[4:7], s55 offen offset:1024 lds
  s_add_u32 s55, s55, 128
  s_add_u32 s100, s100, 172032
  s_cmp_eq_u32 s55, s57
  s_cselect_b32 s55, s56, s55
  s_cselect_b32 s100, s101, s100
  s_waitcnt lgkmcnt(5)
  v_mfma_f32_32x32x16_bf16 v[48:63], a[136:139], v[148:151], v[48:63]
  v_mfma_f32_16x16x32_bf16 v[100:103], v[112:115], v[148:151], v[100:103]
  s_waitcnt vmcnt(12) lgkmcnt(0)
  s_barrier
  s_lshl_b32 s58, s2, 6
  s_add_u32 s58, s58, 131072
  s_lshl_b32 s59, s40, 28
  s_mov_b64 exec, 1
  v_mov_b32 v3, s1
  v_mov_b32 v4, s59
  buffer_store_dword v3, v4, s[12:15], s58 offen sc1
  s_mov_b64 exec, -1
  v_mfma_f32_32x32x16_bf16 v[64:79], a[140:143], a[140:143], v[64:79]
  ds_read_b128 a[144:147], v20 offset:0
  ds_read_b64_tr_b16 v[128:129], v25 offset:8192
  v_mfma_f32_16x16x32_bf16 v[104:107], v[112:115], a[140:143], v[104:107]
  ds_read_b64_tr_b16 v[130:131], v25 offset:8704
  ds_read_b64_tr_b16 v[132:133], v27 offset:16384
  s_add_u32 m0, s52, 31872
  s_nop 0
  buffer_load_dwordx4 v10, s[8:11], s100 offen offset:896 lds
  v_mfma_f32_32x32x16_bf16 v[32:47], a[140:143], v[152:155], v[32:47]
  ds_read_b64_tr_b16 v[134:135], v27 offset:16896
  ds_read_b128 a[148:151], v21 offset:0
  v_mfma_f32_16x16x32_bf16 v[96:99], v[112:115], v[152:155], v[96:99]
  ds_read_b64_tr_b16 v[136:137], v25 offset:10240
  ds_read_b64_tr_b16 v[138:139], v25 offset:10752
  v_mfma_f32_32x32x16_bf16 v[48:63], a[140:143], v[156:159], v[48:63]
  ds_read_b64_tr_b16 v[140:141], v27 offset:18432
  ds_read_b64_tr_b16 v[142:143], v27 offset:18944
  buffer_load_dwordx4 v11, s[8:11], s100 offen offset:1920 lds
  v_mfma_f32_16x16x32_bf16 v[100:103], v[112:115], v[156:159], v[100:103]
  s_waitcnt lgkmcnt(9)
  v_mfma_f32_32x32x16_bf16 v[64:79], a[144:147], a[144:147], v[64:79]
  ds_read_b128 a[152:155], v22 offset:0
  v_mfma_f32_16x16x32_bf16 v[104:107], v[112:115], a[144:147], v[104:107]
  ds_read_b64_tr_b16 v[144:145], v25 offset:12288
  s_add_u32 m0, s52, 39168
  s_nop 0
  buffer_load_dwordx4 v10, s[8:11], s100 offen offset:1792 lds
  s_waitcnt lgkmcnt(9)
  v_mfma_f32_32x32x16_bf16 v[32:47], a[144:147], v[128:131], v[32:47]
  ds_read_b64_tr_b16 v[146:147], v25 offset:12800
  v_mfma_f32_16x16x32_bf16 v[96:99], v[112:115], v[128:131], v[96:99]
  ds_read_b64_tr_b16 v[148:149], v27 offset:20480
  s_waitcnt lgkmcnt(9)
  v_mfma_f32_32x32x16_bf16 v[48:63], a[144:147], v[132:135], v[48:63]
  ds_read_b64_tr_b16 v[150:151], v27 offset:20992
  buffer_load_dwordx4 v11, s[8:11], s100 offen offset:2816 lds
  v_mfma_f32_16x16x32_bf16 v[100:103], v[112:115], v[132:135], v[100:103]
  s_waitcnt lgkmcnt(9)
  v_mfma_f32_32x32x16_bf16 v[64:79], a[148:151], a[148:151], v[64:79]
  ds_read_b128 a[156:159], v23 offset:0
  v_mfma_f32_16x16x32_bf16 v[104:107], v[112:115], a[148:151], v[104:107]
  ds_read_b64_tr_b16 v[152:153], v25 offset:14336
  s_waitcnt lgkmcnt(9)
  v_mfma_f32_32x32x16_bf16 v[32:47], a[148:151], v[136:139], v[32:47]
  ds_read_b64_tr_b16 v[154:155], v25 offset:14848
  v_mfma_f32_16x16x32_bf16 v[96:99], v[112:115], v[136:139], v[96:99]
  ds_read_b64_tr_b16 v[156:157], v27 offset:22528
  s_add_u32 m0, s52, 24576
  s_nop 0
  buffer_load_dwordx4 v8, s[4:7], s55 offen lds
  s_waitcnt lgkmcnt(9)
  v_mfma_f32_32x32x16_bf16 v[48:63], a[148:151], v[140:143], v[48:63]
  ds_read_b64_tr_b16 v[158:159], v27 offset:23040
  v_mfma_f32_16x16x32_bf16 v[100:103], v[112:115], v[140:143], v[100:103]
  s_waitcnt lgkmcnt(9)
  v_mfma_f32_32x32x16_bf16 v[64:79], a[152:155], a[152:155], v[64:79]
  v_mfma_f32_16x16x32_bf16 v[104:107], v[112:115], a[152:155], v[104:107]
  s_waitcnt lgkmcnt(7)
  v_mfma_f32_32x32x16_bf16 v[32:47], a[152:155], v[144:147], v[32:47]
  v_mfma_f32_16x16x32_bf16 v[96:99], v[112:115], v[144:147], v[96:99]
  buffer_load_dwordx4 v9, s[4:7], s55 offen offset:1024 lds
  s_add_u32 s55, s55, 128
  s_add_u32 s100, s100, 172032
  s_cmp_eq_u32 s55, s57
  s_cselect_b32 s55, s56, s55
  s_cselect_b32 s100, s101, s100
  s_waitcnt lgkmcnt(5)
  v_mfma_f32_32x32x16_bf16 v[48:63], a[152:155], v[148:151], v[48:63]
  v_mfma_f32_16x16x32_bf16 v[100:103], v[112:115], v[148:151], v[100:103]
  s_waitcnt vmcnt(13) lgkmcnt(0)
  s_barrier
  v_mfma_f32_32x32x16_bf16 v[64:79], a[156:159], a[156:159], v[64:79]
  ds_read_b128 a[160:163], v20 offset:24576
  ds_read_b64_tr_b16 v[128:129], v25 offset:32768
  v_mfma_f32_16x16x32_bf16 v[104:107], v[112:115], a[156:159], v[104:107]
  ds_read_b64_tr_b16 v[130:131], v25 offset:33280
  ds_read_b64_tr_b16 v[132:133], v27 offset:40960
  s_add_u32 m0, s52, 56448
  s_nop 0
  buffer_load_dwordx4 v10, s[8:11], s100 offen offset:896 lds
  v_mfma_f32_32x32x16_bf16 v[32:47], a[156:159], v[152:155], v[32:47]
  ds_read_b64_tr_b16 v[134:135], v27 offset:41472
  ds_read_b128 a[164:167], v21 offset:24576
  v_mfma_f32_16x16x32_bf16 v[96:99], v[112:115], v[152:155], v[96:99]
  ds_read_b64_tr_b16 v[136:137], v25 offset:34816
  ds_read_b64_tr_b16 v[138:139], v25 offset:35328
  v_mfma_f32_32x32x16_bf16 v[48:63], a[156:159], v[156:159], v[48:63]
  ds_read_b64_tr_b16 v[140:141], v27 offset:43008
  ds_read_b64_tr_b16 v[142:143], v27 offset:43520
  buffer_load_dwordx4 v11, s[8:11], s100 offen offset:1920 lds
  v_mfma_f32_16x16x32_bf16 v[100:103], v[112:115], v[156:159], v[100:103]
  s_waitcnt lgkmcnt(9)
  v_mfma_f32_32x32x16_bf16 v[64:79], a[160:163], a[160:163], v[64:79]
  ds_read_b128 a[168:171], v22 offset:24576
  v_mfma_f32_16x16x32_bf16 v[104:107], v[112:115], a[160:163], v[104:107]
  ds_read_b64_tr_b16 v[144:145], v25 offset:36864
  s_add_u32 m0, s52, 63744
  s_nop 0
  buffer_load_dwordx4 v10, s[8:11], s100 offen offset:1792 lds
  s_waitcnt lgkmcnt(9)
  v_mfma_f32_32x32x16_bf16 v[32:47], a[160:163], v[128:131], v[32:47]
  ds_read_b64_tr_b16 v[146:147], v25 offset:37376
  v_mfma_f32_16x16x32_bf16 v[96:99], v[112:115], v[128:131], v[96:99]
  ds_read_b64_tr_b16 v[148:149], v27 offset:45056
  s_waitcnt lgkmcnt(9)
  v_mfma_f32_32x32x16_bf16 v[48:63], a[160:163], v[132:135], v[48:63]
  ds_read_b64_tr_b16 v[150:151], v27 offset:45568
  buffer_load_dwordx4 v11, s[8:11], s100 offen offset:2816 lds
  v_mfma_f32_16x16x32_bf16 v[100:103], v[112:115], v[132:135], v[100:103]
  s_waitcnt lgkmcnt(9)
  v_mfma_f32_32x32x16_bf16 v[64:79], a[164:167], a[164:167], v[64:79]
  ds_read_b128 a[172:175], v23 offset:24576
  v_mfma_f32_16x16x32_bf16 v[104:107], v[112:115], a[164:167], v[104:107]
  ds_read_b64_tr_b16 v[152:153], v25 offset:38912
  s_waitcnt lgkmcnt(9)
  v_mfma_f32_32x32x16_bf16 v[32:47], a[164:167], v[136:139], v[32:47]
  ds_read_b64_tr_b16 v[154:155], v25 offset:39424
  v_mfma_f32_16x16x32_bf16 v[96:99], v[112:115], v[136:139], v[96:99]
  ds_read_b64_tr_b16 v[156:157], v27 offset:47104
  s_add_u32 m0, s52, 49152
  s_nop 0
  buffer_load_dwordx4 v8, s[4:7], s55 offen lds
  s_waitcnt lgkmcnt(9)
  v_mfma_f32_32x32x16_bf16 v[48:63], a[164:167], v[140:143], v[48:63]
  ds_read_b64_tr_b16 v[158:159], v27 offset:47616
  v_mfma_f32_16x16x32_bf16 v[100:103], v[112:115], v[140:143], v[100:103]
  s_waitcnt lgkmcnt(9)
  v_mfma_f32_32x32x16_bf16 v[64:79], a[168:171], a[168:171], v[64:79]
  v_mfma_f32_16x16x32_bf16 v[104:107], v[112:115], a[168:171], v[104:107]
  s_waitcnt lgkmcnt(7)
  v_mfma_f32_32x32x16_bf16 v[32:47], a[168:171], v[144:147], v[32:47]
  v_mfma_f32_16x16x32_bf16 v[96:99], v[112:115], v[144:147], v[96:99]
  buffer_load_dwordx4 v9, s[4:7], s55 offen offset:1024 lds
  s_add_u32 s55, s55, 128
  s_add_u32 s100, s100, 172032
  s_cmp_eq_u32 s55, s57
  s_cselect_b32 s55, s56, s55
  s_cselect_b32 s100, s101, s100
  s_waitcnt lgkmcnt(5)
  v_mfma_f32_32x32x16_bf16 v[48:63], a[168:171], v[148:151], v[48:63]
  v_mfma_f32_16x16x32_bf16 v[100:103], v[112:115], v[148:151], v[100:103]
  s_waitcnt vmcnt(13) lgkmcnt(0)
  s_barrier
  v_mfma_f32_32x32x16_bf16 v[64:79], a[172:175], a[172:175], v[64:79]
  ds_read_b128 a[176:179], v16 offset:0
  ds_read_b64_tr_b16 v[128:129], v24 offset:8192
  v_mfma_f32_16x16x32_bf16 v[104:107], v[112:115], a[172:175], v[104:107]
  ds_read_b64_tr_b16 v[130:131], v24 offset:8704
  ds_read_b64_tr_b16 v[132:133], v26 offset:16384
  s_add_u32 m0, s52, 81024
  s_nop 0
  buffer_load_dwordx4 v10, s[8:11], s100 offen offset:896 lds
  v_mfma_f32_32x32x16_bf16 v[32:47], a[172:175], v[152:155], v[32:47]
  ds_read_b64_tr_b16 v[134:135], v26 offset:16896
  ds_read_b128 a[180:183], v17 offset:0
  v_mfma_f32_16x16x32_bf16 v[96:99], v[112:115], v[152:155], v[96:99]
  ds_read_b64_tr_b16 v[136:137], v24 offset:10240
  ds_read_b64_tr_b16 v[138:139], v24 offset:10752
  v_mfma_f32_32x32x16_bf16 v[48:63], a[172:175], v[156:159], v[48:63]
  ds_read_b64_tr_b16 v[140:141], v26 offset:18432
  ds_read_b64_tr_b16 v[142:143], v26 offset:18944
  buffer_load_dwordx4 v11, s[8:11], s100 offen offset:1920 lds
  v_mfma_f32_16x16x32_bf16 v[100:103], v[112:115], v[156:159], v[100:103]
  s_waitcnt lgkmcnt(9)
  v_mfma_f32_32x32x16_bf16 v[64:79], a[176:179], a[176:179], v[64:79]
  ds_read_b128 a[184:187], v18 offset:0
  v_mfma_f32_16x16x32_bf16 v[104:107], v[112:115], a[176:179], v[104:107]
  ds_read_b64_tr_b16 v[144:145], v24 offset:12288
  s_add_u32 m0, s52, 88320
  s_nop 0
  buffer_load_dwordx4 v10, s[8:11], s100 offen offset:1792 lds
  s_waitcnt lgkmcnt(9)
  v_mfma_f32_32x32x16_bf16 v[32:47], a[176:179], v[128:131], v[32:47]
  ds_read_b64_tr_b16 v[146:147], v24 offset:12800
  v_mfma_f32_16x16x32_bf16 v[96:99], v[112:115], v[128:131], v[96:99]
  ds_read_b64_tr_b16 v[148:149], v26 offset:20480
  s_waitcnt lgkmcnt(9)
  v_mfma_f32_32x32x16_bf16 v[48:63], a[176:179], v[132:135], v[48:63]
  ds_read_b64_tr_b16 v[150:151], v26 offset:20992
  buffer_load_dwordx4 v11, s[8:11], s100 offen offset:2816 lds
  v_mfma_f32_16x16x32_bf16 v[100:103], v[112:115], v[132:135], v[100:103]
  s_waitcnt lgkmcnt(9)
  v_mfma_f32_32x32x16_bf16 v[64:79], a[180:183], a[180:183], v[64:79]
  ds_read_b128 a[188:191], v19 offset:0
  v_mfma_f32_16x16x32_bf16 v[104:107], v[112:115], a[180:183], v[104:107]
  ds_read_b64_tr_b16 v[152:153], v24 offset:14336
  s_waitcnt lgkmcnt(9)
  v_mfma_f32_32x32x16_bf16 v[32:47], a[180:183], v[136:139], v[32:47]
  ds_read_b64_tr_b16 v[154:155], v24 offset:14848
  v_mfma_f32_16x16x32_bf16 v[96:99], v[112:115], v[136:139], v[96:99]
  ds_read_b64_tr_b16 v[156:157], v26 offset:22528
  s_add_u32 m0, s52, 73728
  s_nop 0
  buffer_load_dwordx4 v8, s[4:7], s55 offen lds
  s_waitcnt lgkmcnt(9)
  v_mfma_f32_32x32x16_bf16 v[48:63], a[180:183], v[140:143], v[48:63]
  ds_read_b64_tr_b16 v[158:159], v26 offset:23040
  v_mfma_f32_16x16x32_bf16 v[100:103], v[112:115], v[140:143], v[100:103]
  s_waitcnt lgkmcnt(9)
  v_mfma_f32_32x32x16_bf16 v[64:79], a[184:187], a[184:187], v[64:79]
  v_mfma_f32_16x16x32_bf16 v[104:107], v[112:115], a[184:187], v[104:107]
  s_waitcnt lgkmcnt(7)
  v_mfma_f32_32x32x16_bf16 v[32:47], a[184:187], v[144:147], v[32:47]
  v_mfma_f32_16x16x32_bf16 v[96:99], v[112:115], v[144:147], v[96:99]
  buffer_load_dwordx4 v9, s[4:7], s55 offen offset:1024 lds
  s_add_u32 s55, s55, 128
  s_add_u32 s100, s100, 172032
  s_cmp_eq_u32 s55, s57
  s_cselect_b32 s55, s56, s55
  s_cselect_b32 s100, s101, s100
  s_waitcnt lgkmcnt(5)
  v_mfma_f32_32x32x16_bf16 v[48:63], a[184:187], v[148:151], v[48:63]
  v_mfma_f32_16x16x32_bf16 v[100:103], v[112:115], v[148:151], v[100:103]
  s_waitcnt vmcnt(12) lgkmcnt(0)
  s_barrier
  v_mfma_f32_32x32x16_bf16 v[64:79], a[188:191], a[188:191], v[64:79]
  ds_read_b128 a[192:195], v16 offset:24576
  ds_read_b64_tr_b16 v[128:129], v24 offset:32768
  v_mfma_f32_16x16x32_bf16 v[104:107], v[112:115], a[188:191], v[104:107]
  ds_read_b64_tr_b16 v[130:131], v24 offset:33280
  ds_read_b64_tr_b16 v[132:133], v26 offset:40960
  s_add_u32 m0, s52, 106496
  s_nop 0
  buffer_load_dwordx4 v10, s[8:11], s16 offen lds
  v_mfma_f32_32x32x16_bf16 v[32:47], a[188:191], v[152:155], v[32:47]
  ds_read_b64_tr_b16 v[134:135], v26 offset:41472
  ds_read_b128 a[196:199], v17 offset:24576
  v_mfma_f32_16x16x32_bf16 v[96:99], v[112:115], v[152:155], v[96:99]
  ds_read_b64_tr_b16 v[136:137], v24 offset:34816
  ds_read_b64_tr_b16 v[138:139], v24 offset:35328
  v_mfma_f32_32x32x16_bf16 v[48:63], a[188:191], v[156:159], v[48:63]
  ds_read_b64_tr_b16 v[140:141], v26 offset:43008
  ds_read_b64_tr_b16 v[142:143], v26 offset:43520
  buffer_load_dwordx4 v11, s[8:11], s16 offen offset:1024 lds
  s_add_u32 s16, s16, 172032
  s_cmp_eq_u32 s16, s17
  s_cselect_b32 s16, s101, s16
  v_mfma_f32_16x16x32_bf16 v[100:103], v[112:115], v[156:159], v[100:103]
  s_waitcnt lgkmcnt(9)
  v_mfma_f32_32x32x16_bf16 v[64:79], a[192:195], a[192:195], v[64:79]
  ds_read_b128 a[200:203], v18 offset:24576
  v_mfma_f32_16x16x32_bf16 v[104:107], v[112:115], a[192:195], v[104:107]
  ds_read_b64_tr_b16 v[144:145], v24 offset:36864
  s_add_u32 m0, s52, 114688
  s_nop 0
  buffer_load_dwordx4 v10, s[8:11], s16 offen lds
  s_waitcnt lgkmcnt(9)
  v_mfma_f32_32x32x16_bf16 v[32:47], a[192:195], v[128:131], v[32:47]
  ds_read_b64_tr_b16 v[146:147], v24 offset:37376
  v_mfma_f32_16x16x32_bf16 v[96:99], v[112:115], v[128:131], v[96:99]
  ds_read_b64_tr_b16 v[148:149], v26 offset:45056
  s_waitcnt lgkmcnt(9)
  v_mfma_f32_32x32x16_bf16 v[48:63], a[192:195], v[132:135], v[48:63]
  ds_read_b64_tr_b16 v[150:151], v26 offset:45568
  buffer_load_dwordx4 v11, s[8:11], s16 offen offset:1024 lds
  s_add_u32 s16, s16, 172032
  s_cmp_eq_u32 s16, s17
  s_cselect_b32 s16, s101, s16
  v_mfma_f32_16x16x32_bf16 v[100:103], v[112:115], v[132:135], v[100:103]
  s_waitcnt lgkmcnt(9)
  v_mfma_f32_32x32x16_bf16 v[64:79], a[196:199], a[196:199], v[64:79]
  ds_read_b128 a[204:207], v19 offset:24576
  v_mfma_f32_16x16x32_bf16 v[104:107], v[112:115], a[196:199], v[104:107]
  ds_read_b64_tr_b16 v[152:153], v24 offset:38912
  s_add_u32 m0, s52, 122880
  s_nop 0
  buffer_load_dwordx4 v10, s[8:11], s16 offen lds
  s_waitcnt lgkmcnt(9)
  v_mfma_f32_32x32x16_bf16 v[32:47], a[196:199], v[136:139], v[32:47]
  ds_read_b64_tr_b16 v[154:155], v24 offset:39424
  v_mfma_f32_16x16x32_bf16 v[96:99], v[112:115], v[136:139], v[96:99]
  ds_read_b64_tr_b16 v[156:157], v26 offset:47104
  s_waitcnt lgkmcnt(9)
  v_mfma_f32_32x32x16_bf16 v[48:63], a[196:199], v[140:143], v[48:63]
  ds_read_b64_tr_b16 v[158:159], v26 offset:47616
  buffer_load_dwordx4 v11, s[8:11], s16 offen offset:1024 lds
  s_add_u32 s16, s16, 172032
  s_cmp_eq_u32 s16, s17
  s_cselect_b32 s16, s101, s16
  v_mfma_f32_16x16x32_bf16 v[100:103], v[112:115], v[140:143], v[100:103]
  s_waitcnt lgkmcnt(9)
  v_mfma_f32_32x32x16_bf16 v[64:79], a[200:203], a[200:203], v[64:79]
  v_mfma_f32_16x16x32_bf16 v[104:107], v[112:115], a[200:203], v[104:107]
  s_add_u32 m0, s52, 131072
  s_nop 0
  buffer_load_dwordx4 v10, s[8:11], s16 offen lds
  s_waitcnt lgkmcnt(7)
  v_mfma_f32_32x32x16_bf16 v[32:47], a[200:203], v[144:147], v[32:47]
  v_mfma_f32_16x16x32_bf16 v[96:99], v[112:115], v[144:147], v[96:99]
  s_waitcnt lgkmcnt(5)
  v_mfma_f32_32x32x16_bf16 v[48:63], a[200:203], v[148:151], v[48:63]
  buffer_load_dwordx4 v11, s[8:11], s16 offen offset:1024 lds
  s_add_u32 s16, s16, 172032
  s_cmp_eq_u32 s16, s17
  s_cselect_b32 s16, s101, s16
  v_mfma_f32_16x16x32_bf16 v[100:103], v[112:115], v[148:151], v[100:103]
  s_branch L_ov1
  .p2align 12
L_pg1:
  s_branch L_bk1
L_ov1:
  s_waitcnt vmcnt(14) lgkmcnt(0)
  s_barrier
  v_mfma_f32_32x32x16_bf16 v[64:79], a[204:207], a[204:207], v[64:79]
  ds_read_b128 a[208:211], v20 offset:0
  ds_read_b64_tr_b16 v[128:129], v25 offset:8192
  v_mfma_f32_16x16x32_bf16 v[104:107], v[112:115], a[204:207], v[104:107]
  ds_read_b64_tr_b16 v[130:131], v25 offset:8704
  ds_read_b64_tr_b16 v[132:133], v27 offset:16384
  s_add_u32 m0, s52, 139264
  s_nop 0
  buffer_load_dwordx4 v10, s[8:11], s16 offen lds
  v_mfma_f32_32x32x16_bf16 v[32:47], a[204:207], v[152:155], v[32:47]
  ds_read_b64_tr_b16 v[134:135], v27 offset:16896
  ds_read_b128 a[212:215], v21 offset:0
  v_mfma_f32_16x16x32_bf16 v[96:99], v[112:115], v[152:155], v[96:99]
  ds_read_b64_tr_b16 v[136:137], v25 offset:10240
  ds_read_b64_tr_b16 v[138:139], v25 offset:10752
  v_mfma_f32_32x32x16_bf16 v[48:63], a[204:207], v[156:159], v[48:63]
  ds_read_b64_tr_b16 v[140:141], v27 offset:18432
  ds_read_b64_tr_b16 v[142:143], v27 offset:18944
  buffer_load_dwordx4 v11, s[8:11], s16 offen offset:1024 lds
  s_add_u32 s16, s16, 172032
  s_cmp_eq_u32 s16, s17
  s_cselect_b32 s16, s101, s16
  v_mfma_f32_16x16x32_bf16 v[100:103], v[112:115], v[156:159], v[100:103]
  s_waitcnt lgkmcnt(9)
  v_mfma_f32_32x32x16_bf16 v[64:79], a[208:211], a[208:211], v[64:79]
  ds_read_b128 a[216:219], v22 offset:0
  v_mfma_f32_16x16x32_bf16 v[104:107], v[112:115], a[208:211], v[104:107]
  ds_read_b64_tr_b16 v[144:145], v25 offset:12288
  s_add_u32 m0, s52, 147456
  s_nop 0
  buffer_load_dwordx4 v10, s[8:11], s16 offen lds
  s_waitcnt lgkmcnt(9)
  v_mfma_f32_32x32x16_bf16 v[32:47], a[208:211], v[128:131], v[32:47]
  ds_read_b64_tr_b16 v[146:147], v25 offset:12800
  v_mfma_f32_16x16x32_bf16 v[96:99], v[112:115], v[128:131], v[96:99]
  ds_read_b64_tr_b16 v[148:149], v27 offset:20480
  s_waitcnt lgkmcnt(9)
  v_mfma_f32_32x32x16_bf16 v[48:63], a[208:211], v[132:135], v[48:63]
  ds_read_b64_tr_b16 v[150:151], v27 offset:20992
  buffer_load_dwordx4 v11, s[8:11], s16 offen offset:1024 lds
  s_add_u32 s16, s16, 172032
  s_cmp_eq_u32 s16, s17
  s_cselect_b32 s16, s101, s16
  v_mfma_f32_16x16x32_bf16 v[100:103], v[112:115], v[132:135], v[100:103]
  s_waitcnt lgkmcnt(9)
  v_mfma_f32_32x32x16_bf16 v[64:79], a[212:215], a[212:215], v[64:79]
  ds_read_b128 a[220:223], v23 offset:0
  v_mfma_f32_16x16x32_bf16 v[104:107], v[112:115], a[212:215], v[104:107]
  ds_read_b64_tr_b16 v[152:153], v25 offset:14336
  s_waitcnt lgkmcnt(9)
  v_mfma_f32_32x32x16_bf16 v[32:47], a[212:215], v[136:139], v[32:47]
  ds_read_b64_tr_b16 v[154:155], v25 offset:14848
  v_mfma_f32_16x16x32_bf16 v[96:99], v[112:115], v[136:139], v[96:99]
  ds_read_b64_tr_b16 v[156:157], v27 offset:22528
  s_add_u32 m0, s52, 155648
  s_nop 0
  buffer_load_dwordx4 v10, s[8:11], s16 offen lds
  s_waitcnt lgkmcnt(9)
  v_mfma_f32_32x32x16_bf16 v[48:63], a[212:215], v[140:143], v[48:63]
  ds_read_b64_tr_b16 v[158:159], v27 offset:23040
  v_mfma_f32_16x16x32_bf16 v[100:103], v[112:115], v[140:143], v[100:103]
  s_waitcnt lgkmcnt(9)
  v_mfma_f32_32x32x16_bf16 v[64:79], a[216:219], a[216:219], v[64:79]
  v_mfma_f32_16x16x32_bf16 v[104:107], v[112:115], a[216:219], v[104:107]
  s_waitcnt lgkmcnt(7)
  v_mfma_f32_32x32x16_bf16 v[32:47], a[216:219], v[144:147], v[32:47]
  v_mfma_f32_16x16x32_bf16 v[96:99], v[112:115], v[144:147], v[96:99]
  buffer_load_dwordx4 v11, s[8:11], s16 offen offset:1024 lds
  s_add_u32 s16, s16, 172032
  s_cmp_eq_u32 s16, s17
  s_cselect_b32 s16, s101, s16
  s_waitcnt lgkmcnt(5)
  v_mfma_f32_32x32x16_bf16 v[48:63], a[216:219], v[148:151], v[48:63]
  v_mfma_f32_16x16x32_bf16 v[100:103], v[112:115], v[148:151], v[100:103]
  s_waitcnt vmcnt(14) lgkmcnt(0)
  s_barrier
  v_lshlrev_b32 v14, 6, v0
  s_mov_b32 s49, 131072
  buffer_load_dword v13, v14, s[12:15], s49 offen sc1
  v_mfma_f32_32x32x16_bf16 v[64:79], a[220:223], a[220:223], v[64:79]
  ds_read_b128 a[224:227], v20 offset:24576
  ds_read_b128 a[228:231], v21 offset:24576
  v_mfma_f32_16x16x32_bf16 v[104:107], v[112:115], a[220:223], v[104:107]
  ds_read_b128 a[232:235], v22 offset:24576
  ds_read_b128 a[236:239], v23 offset:24576
  s_mov_b32 exec_lo, 0x7f7f7f7f
  s_mov_b32 exec_hi, 0x7f7f7f7f
  buffer_load_dword v119, v31, s[20:23], 0 offen
  s_mov_b64 exec, -1
  v_mfma_f32_32x32x16_bf16 v[32:47], a[220:223], v[152:155], v[32:47]
  ds_read_b64_tr_b16 v[128:129], v25 offset:32768
  ds_read_b64_tr_b16 v[130:131], v25 offset:33280
  v_mfma_f32_16x16x32_bf16 v[96:99], v[112:115], v[152:155], v[96:99]
  ds_read_b64_tr_b16 v[132:133], v27 offset:40960
  ds_read_b64_tr_b16 v[134:135], v27 offset:41472
  v_mfma_f32_32x32x16_bf16 v[48:63], a[220:223], v[156:159], v[48:63]
  ds_read_b64_tr_b16 v[136:137], v25 offset:34816
  ds_read_b64_tr_b16 v[138:139], v25 offset:35328
  v_mfma_f32_16x16x32_bf16 v[100:103], v[112:115], v[156:159], v[100:103]
  s_waitcnt lgkmcnt(9)
  v_mfma_f32_32x32x16_bf16 v[64:79], a[224:227], a[224:227], v[64:79]
  ds_read_b64_tr_b16 v[140:141], v27 offset:43008
  ds_read_b64_tr_b16 v[142:143], v27 offset:43520
  v_mfma_f32_16x16x32_bf16 v[104:107], v[112:115], a[224:227], v[104:107]
  ds_read_b64_tr_b16 v[144:145], v25 offset:36864
  ds_read_b64_tr_b16 v[146:147], v25 offset:37376
  s_waitcnt lgkmcnt(12)
  v_mfma_f32_32x32x16_bf16 v[64:79], a[228:231], a[228:231], v[64:79]
  ds_read_b64_tr_b16 v[148:149], v27 offset:45056
  ds_read_b64_tr_b16 v[150:151], v27 offset:45568
  v_mfma_f32_16x16x32_bf16 v[104:107], v[112:115], a[228:231], v[104:107]
  ds_read_b64_tr_b16 v[152:153], v25 offset:38912
  ds_read_b64_tr_b16 v[154:155], v25 offset:39424
  s_waitcnt lgkmcnt(15)
  v_mfma_f32_32x32x16_bf16 v[64:79], a[232:235], a[232:235], v[64:79]
  ds_read_b64_tr_b16 v[156:157], v27 offset:47104
  ds_read_b64_tr_b16 v[158:159], v27 offset:47616
  v_mfma_f32_16x16x32_bf16 v[104:107], v[112:115], a[232:235], v[104:107]
  s_waitcnt lgkmcnt(15)
  v_mfma_f32_32x32x16_bf16 v[64:79], a[236:239], a[236:239], v[64:79]
  v_mfma_f32_16x16x32_bf16 v[104:107], v[112:115], a[236:239], v[104:107]
  s_waitcnt lgkmcnt(14)
  v_mfma_f32_16x16x32_bf16 v[96:99], v[112:115], v[128:131], v[96:99]
  v_mov_b32 v163, 0
  v_mov_b32 v164, 0
  s_waitcnt lgkmcnt(12)
  v_mfma_f32_16x16x32_bf16 v[100:103], v[112:115], v[132:135], v[100:103]
  v_mov_b32 v165, 0
  v_mov_b32 v166, 1065369472
  s_waitcnt lgkmcnt(10)
  v_mfma_f32_16x16x32_bf16 v[96:99], v[112:115], v[136:139], v[96:99]
  v_mov_b32 v167, 0
  v_mov_b32 v170, 0x358637bd
  s_waitcnt lgkmcnt(8)
  v_mfma_f32_16x16x32_bf16 v[100:103], v[112:115], v[140:143], v[100:103]
  v_mov_b32 v172, 0x3fb8aa3b
  v_mov_b32 v194, 0
  s_waitcnt lgkmcnt(6)
  v_mfma_f32_16x16x32_bf16 v[96:99], v[112:115], v[144:147], v[96:99]
  v_mov_b32 v195, 0
  v_mov_b32 v198, 0
  s_waitcnt lgkmcnt(4)
  v_mfma_f32_16x16x32_bf16 v[100:103], v[112:115], v[148:151], v[100:103]
  v_mov_b32 v199, 0
  s_waitcnt lgkmcnt(2)
  v_mfma_f32_16x16x32_bf16 v[96:99], v[112:115], v[152:155], v[96:99]
  v_mov_b32 v202, 0
  s_waitcnt lgkmcnt(0)
  v_mfma_f32_16x16x32_bf16 v[100:103], v[112:115], v[156:159], v[100:103]
  v_mov_b32 v203, 0
  v_mfma_f32_32x32x16_bf16 v[32:47], a[224:227], v[128:131], v[32:47]
  s_mov_b32 vcc_lo, 0xaaaaaaaa
  s_mov_b32 vcc_hi, 0xaaaaaaaa
  v_cndmask_b32 v64, v64, v65
  v_cndmask_b32 v66, v66, v67
  v_cndmask_b32 v68, v68, v69
  v_cndmask_b32 v70, v70, v71
  v_cndmask_b32 v72, v72, v73
  v_cndmask_b32 v74, v74, v75
  v_mfma_f32_32x32x16_bf16 v[32:47], a[228:231], v[136:139], v[32:47]
  v_cndmask_b32 v76, v76, v77
  v_cndmask_b32 v78, v78, v79
  s_mov_b32 vcc_lo, 0xcccccccc
  s_mov_b32 vcc_hi, 0xcccccccc
  v_cndmask_b32 v64, v64, v66
  v_cndmask_b32 v68, v68, v70
  v_cndmask_b32 v72, v72, v74
  v_cndmask_b32 v76, v76, v78
  v_mfma_f32_32x32x16_bf16 v[32:47], a[232:235], v[144:147], v[32:47]
  s_mov_b32 vcc_lo, 0xff00ff00
  s_mov_b32 vcc_hi, 0xff00ff00
  v_cndmask_b32 v64, v64, v68
  v_cndmask_b32 v72, v72, v76
  s_mov_b32 vcc_lo, 0xffff0000
  s_mov_b32 vcc_hi, 0xffff0000
  v_cndmask_b32 v64, v64, v72
  v_mov_b32 v65, v64
  v_mfma_f32_32x32x16_bf16 v[32:47], a[236:239], v[152:155], v[32:47]
  s_mov_b32 vcc_lo, 0xf0f0f0f0
  s_mov_b32 vcc_hi, 0xf0f0f0f0
  v_mul_f32 v104, 0xbb124925, v104
  v_permlane32_swap_b32 v64, v65
  v_mul_f32 v105, 0.5, v104
  v_cndmask_b32 v64, v64, v65
  v_cvt_pk_bf16_f32 v160, v105, v105
  v_mfma_f32_32x32x16_bf16 v[48:63], a[224:227], v[132:135], v[48:63]
  v_mul_f32 v64, 0x3b124925, v64
  v_lshlrev_b32 v106, 16, v160
  v_fma_f32 v168, -v104, v104, v64
  v_sub_f32 v106, v105, v106
  v_max_f32 v168, 0, v168
  v_add_f32 v168, 0x3727c5ac, v168
  v_mfma_f32_32x32x16_bf16 v[48:63], a[228:231], v[140:143], v[48:63]
  v_rsq_f32 v168, v168
  v_cvt_pk_bf16_f32 v161, v106, v106
  v_mul_f32 v104, 0.5, v168
  v_cvt_pk_bf16_f32 v105, v104, v104
  v_lshlrev_b32 v105, 16, v105
  v_sub_f32 v105, v104, v105
  v_mfma_f32_32x32x16_bf16 v[48:63], a[232:235], v[148:151], v[48:63]
  v_cvt_pk_bf16_f32 v162, v104, v105
  v_cvt_pk_bf16_f32 v97, v96, v96
  v_lshlrev_b32 v97, 16, v97
  v_sub_f32 v97, v96, v97
  v_cvt_pk_bf16_f32 v192, v96, v97
  v_cvt_pk_bf16_f32 v193, v96, v97
  v_mfma_f32_32x32x16_bf16 v[64:79], v[160:163], v[164:167], 0
  s_nop 0
  v_mfma_f32_32x32x16_bf16 v[32:47], v[160:163], v[192:195], v[32:47]
  v_cvt_pk_bf16_f32 v101, v100, v100
  v_lshlrev_b32 v101, 16, v101
  v_sub_f32 v101, v100, v101
  v_cvt_pk_bf16_f32 v196, v100, v101
  v_cvt_pk_bf16_f32 v197, v100, v101
  v_mfma_f32_32x32x16_bf16 v[48:63], a[236:239], v[156:159], v[48:63]
  s_nop 0
  v_mfma_f32_32x32x16_bf16 v[48:63], v[160:163], v[196:199], v[48:63]
  v_and_b32 v4, 31, v1
  v_subrev_u32 v5, 24, v4
  v_lshlrev_b32 v5, 2, v5
  v_mov_b32 v6, 0x62735410
  v_lshrrev_b32 v6, v5, v6
  v_cmp_le_u32 vcc, 24, v4
  s_nop 1
  v_cndmask_b32 v4, v4, v6
  v_and_b32 v4, 7, v4
  v_lshrrev_b32 v5, 3, v1
  v_lshlrev_b32 v5, 13, v5
  v_lshl_add_u32 v5, v4, 4, v5
  s_add_u32 s58, s52, 98304
  v_add_u32 v6, s58, v2
  v_xor_b32 v7, 4096, v6
  v_pk_fma_f32 v[32:33], v[32:33], v[64:65], v[170:171] op_sel_hi:[1,1,0]
  v_pk_fma_f32 v[34:35], v[34:35], v[66:67], v[170:171] op_sel_hi:[1,1,0]
  v_pk_fma_f32 v[36:37], v[36:37], v[68:69], v[170:171] op_sel_hi:[1,1,0]
  v_pk_fma_f32 v[38:39], v[38:39], v[70:71], v[170:171] op_sel_hi:[1,1,0]
  v_pk_fma_f32 v[40:41], v[40:41], v[72:73], v[170:171] op_sel_hi:[1,1,0]
  v_pk_fma_f32 v[42:43], v[42:43], v[74:75], v[170:171] op_sel_hi:[1,1,0]
  v_pk_fma_f32 v[44:45], v[44:45], v[76:77], v[170:171] op_sel_hi:[1,1,0]
  v_pk_fma_f32 v[46:47], v[46:47], v[78:79], v[170:171] op_sel_hi:[1,1,0]
  v_pk_mul_f32 v[176:177], v[32:33], v[172:173] op_sel_hi:[1,0]
  v_pk_mul_f32 v[178:179], v[34:35], v[172:173] op_sel_hi:[1,0]
  v_pk_mul_f32 v[180:181], v[36:37], v[172:173] op_sel_hi:[1,0]
  v_pk_mul_f32 v[182:183], v[38:39], v[172:173] op_sel_hi:[1,0]
  v_pk_mul_f32 v[184:185], v[40:41], v[172:173] op_sel_hi:[1,0]
  v_pk_mul_f32 v[186:187], v[42:43], v[172:173] op_sel_hi:[1,0]
  v_pk_mul_f32 v[188:189], v[44:45], v[172:173] op_sel_hi:[1,0]
  v_pk_mul_f32 v[190:191], v[46:47], v[172:173] op_sel_hi:[1,0]
  v_exp_f32_e64 v176, v176 clamp
  v_max_f32 v32, v32, v170
  v_exp_f32_e64 v177, v177 clamp
  v_max_f32 v33, v33, v170
  v_exp_f32_e64 v178, v178 clamp
  v_max_f32 v34, v34, v170
  v_exp_f32_e64 v179, v179 clamp
  v_max_f32 v35, v35, v170
  v_exp_f32_e64 v180, v180 clamp
  v_max_f32 v36, v36, v170
  v_exp_f32_e64 v181, v181 clamp
  v_max_f32 v37, v37, v170
  v_exp_f32_e64 v182, v182 clamp
  v_max_f32 v38, v38, v170
  v_exp_f32_e64 v183, v183 clamp
  v_max_f32 v39, v39, v170
  v_exp_f32_e64 v184, v184 clamp
  v_max_f32 v40, v40, v170
  v_exp_f32_e64 v185, v185 clamp
  v_max_f32 v41, v41, v170
  v_exp_f32_e64 v186, v186 clamp
  v_max_f32 v42, v42, v170
  v_exp_f32_e64 v187, v187 clamp
  v_max_f32 v43, v43, v170
  v_exp_f32_e64 v188, v188 clamp
  v_max_f32 v44, v44, v170
  v_exp_f32_e64 v189, v189 clamp
  v_max_f32 v45, v45, v170
  v_exp_f32_e64 v190, v190 clamp
  v_max_f32 v46, v46, v170
  v_exp_f32_e64 v191, v191 clamp
  v_max_f32 v47, v47, v170
  v_pk_add_f32 v[32:33], v[32:33], v[176:177]
  v_pk_add_f32 v[34:35], v[34:35], v[178:179]
  v_pk_add_f32 v[36:37], v[36:37], v[180:181]
  v_pk_add_f32 v[38:39], v[38:39], v[182:183]
  v_pk_add_f32 v[40:41], v[40:41], v[184:185]
  v_pk_add_f32 v[42:43], v[42:43], v[186:187]
  v_pk_add_f32 v[44:45], v[44:45], v[188:189]
  v_pk_add_f32 v[46:47], v[46:47], v[190:191]
  v_cvt_pk_bf16_f32 v208, v32, v33
  v_cvt_pk_bf16_f32 v209, v34, v35
  v_cvt_pk_bf16_f32 v210, v36, v37
  v_cvt_pk_bf16_f32 v211, v38, v39
  v_cvt_pk_bf16_f32 v212, v40, v41
  v_cvt_pk_bf16_f32 v213, v42, v43
  v_cvt_pk_bf16_f32 v214, v44, v45
  v_cvt_pk_bf16_f32 v215, v46, v47
  v_pk_mul_f32 v[48:49], v[48:49], v[64:65]
  v_pk_mul_f32 v[50:51], v[50:51], v[66:67]
  v_pk_mul_f32 v[52:53], v[52:53], v[68:69]
  v_pk_mul_f32 v[54:55], v[54:55], v[70:71]
  v_pk_mul_f32 v[56:57], v[56:57], v[72:73]
  v_pk_mul_f32 v[58:59], v[58:59], v[74:75]
  v_pk_mul_f32 v[60:61], v[60:61], v[76:77]
  v_pk_mul_f32 v[62:63], v[62:63], v[78:79]
  s_mov_b32 vcc_lo, 0x30000000
  s_mov_b32 vcc_hi, 0x30000000
  v_cvt_pk_bf16_f32 v216, v48, v49
  v_cvt_pk_bf16_f32 v217, v50, v51
  v_cvt_pk_bf16_f32 v218, v52, v53
  v_cvt_pk_bf16_f32 v219, v54, v55
  v_cvt_pk_bf16_f32 v220, v56, v57
  v_cvt_pk_bf16_f32 v221, v58, v59
  v_cvt_pk_bf16_f32 v222, v60, v61
  v_cvt_pk_bf16_f32 v223, v62, v63
  v_cndmask_b32 v216, v216, v166
  v_cndmask_b32 v217, v217, v166
  v_cndmask_b32 v218, v218, v166
  v_cndmask_b32 v219, v219, v166
  v_cndmask_b32 v220, v220, v166
  v_cndmask_b32 v221, v221, v166
  v_mfma_f32_32x32x16_bf16 v[32:47], v[208:211], v[216:219], 0
  v_cndmask_b32 v222, v222, v166
  v_cndmask_b32 v223, v223, v166
  s_nop 1
  v_mfma_f32_32x32x16_bf16 v[32:47], v[212:215], v[220:223], v[32:47]
  s_lshl_b32 s58, s42, 1
  s_and_b32 s59, s40, 1
  s_add_u32 s42, s58, s59
  s_lshl_b32 s58, s42, 17
  s_lshr_b32 s59, s40, 1
  s_lshl_b32 s48, s59, 16
  s_add_u32 s58, s58, s48
  s_lshl_b32 s48, s41, 8
  s_add_u32 s58, s58, s48
  s_add_u32 s58, s58, 16777216
  s_lshl_b32 s41, s41, 1
  s_add_u32 s41, s41, s59
  s_lshl_b32 s41, s41, 4
  s_add_u32 s41, s41, s42
  ds_write_b128 v6, v[40:43] offset:0
  ds_write_b128 v6, v[44:47] offset:1024
  s_waitcnt lgkmcnt(0)
  s_barrier
  ds_read_b128 v[48:51], v7 offset:0
  ds_read_b128 v[52:55], v7 offset:1024
  s_waitcnt lgkmcnt(1)
  v_pk_add_f32 v[32:33], v[32:33], v[48:49]
  v_pk_add_f32 v[34:35], v[34:35], v[50:51]
  s_waitcnt lgkmcnt(0)
  v_pk_add_f32 v[36:37], v[36:37], v[52:53]
  v_pk_add_f32 v[38:39], v[38:39], v[54:55]
  v_mov_b32_sdwa v32, s1 dst_sel:BYTE_0 dst_unused:UNUSED_PRESERVE src0_sel:BYTE_0
  v_mov_b32_sdwa v33, s1 dst_sel:BYTE_0 dst_unused:UNUSED_PRESERVE src0_sel:BYTE_1
  v_mov_b32_sdwa v34, s1 dst_sel:BYTE_0 dst_unused:UNUSED_PRESERVE src0_sel:BYTE_2
  v_mov_b32_sdwa v35, s1 dst_sel:BYTE_0 dst_unused:UNUSED_PRESERVE src0_sel:BYTE_3
  buffer_store_dwordx4 v[32:35], v5, s[12:15], s58 offen offset:0 sc1
  v_mov_b32_sdwa v36, s1 dst_sel:BYTE_0 dst_unused:UNUSED_PRESERVE src0_sel:BYTE_0
  v_mov_b32_sdwa v37, s1 dst_sel:BYTE_0 dst_unused:UNUSED_PRESERVE src0_sel:BYTE_1
  v_mov_b32_sdwa v38, s1 dst_sel:BYTE_0 dst_unused:UNUSED_PRESERVE src0_sel:BYTE_2
  v_mov_b32_sdwa v39, s1 dst_sel:BYTE_0 dst_unused:UNUSED_PRESERVE src0_sel:BYTE_3
  buffer_store_dwordx4 v[36:39], v5, s[12:15], s58 offen offset:128 sc1
  s_waitcnt vmcnt(4) lgkmcnt(0)
  s_barrier
  ds_read_b64_tr_b16 v[128:129], v116 offset:0
  ds_read_b64_tr_b16 v[130:131], v116 offset:512
  ds_read_b64_tr_b16 v[132:133], v116 offset:2048
  ds_read_b64_tr_b16 v[134:135], v116 offset:2560
  ds_read_b64_tr_b16 v[136:137], v116 offset:4096
  ds_read_b64_tr_b16 v[138:139], v116 offset:4608
  ds_read_b64_tr_b16 v[140:141], v116 offset:6144
  ds_read_b64_tr_b16 v[142:143], v116 offset:6656
  ds_read_b64_tr_b16 v[144:145], v116 offset:8192
  ds_read_b64_tr_b16 v[146:147], v116 offset:8704
  s_mov_b32 s48, 262144
L_flz:
  s_waitcnt vmcnt(3)
  v_cmp_ne_u32 vcc, s1, v13
  s_cbranch_vccz L_flzx
  buffer_load_dword v13, v14, s[12:15], s49 offen sc1
  s_sub_u32 s48, s48, 1
  s_waitcnt vmcnt(0)
  s_cbranch_scc0 L_flz
L_flzx:
  s_waitcnt lgkmcnt(8)
  v_mfma_f32_16x16x32_bf16 v[108:111], v[112:115], v[128:131], 0
  ds_read_b64_tr_b16 v[148:149], v116 offset:10240
  v_mfma_f32_32x32x16_bf16 v[80:95], v[128:131], a[128:131], 0
  ds_read_b64_tr_b16 v[150:151], v116 offset:10752
  s_lshl_b32 s55, s2, 13
  s_lshl_b32 s48, s40, 5
  s_add_u32 s55, s55, s48
  s_waitcnt lgkmcnt(8)
  v_mfma_f32_16x16x32_bf16 v[108:111], v[112:115], v[132:135], v[108:111]
  ds_read_b64_tr_b16 v[152:153], v116 offset:12288
  v_mfma_f32_32x32x16_bf16 v[80:95], v[132:135], a[132:135], v[80:95]
  ds_read_b64_tr_b16 v[154:155], v116 offset:12800
  s_add_u32 s55, s55, 16777216
  s_add_u32 s57, s55, 4096
  s_waitcnt lgkmcnt(8)
  v_mfma_f32_16x16x32_bf16 v[108:111], v[112:115], v[136:139], v[108:111]
  ds_read_b64_tr_b16 v[156:157], v116 offset:14336
  v_mfma_f32_32x32x16_bf16 v[80:95], v[136:139], a[136:139], v[80:95]
  ds_read_b64_tr_b16 v[158:159], v116 offset:14848
  s_lshl_b32 s56, s2, 7
  s_add_u32 s56, s56, s48
  s_add_u32 s56, s56, 1048576
  s_waitcnt lgkmcnt(8)
  v_mfma_f32_16x16x32_bf16 v[108:111], v[112:115], v[140:143], v[108:111]
  ds_read_b64_tr_b16 v[128:129], v116 offset:16384
  v_mfma_f32_32x32x16_bf16 v[80:95], v[140:143], a[140:143], v[80:95]
  ds_read_b64_tr_b16 v[130:131], v116 offset:16896
  v_lshrrev_b32 v4, 1, v1
  s_waitcnt lgkmcnt(8)
  v_mfma_f32_16x16x32_bf16 v[108:111], v[112:115], v[144:147], v[108:111]
  ds_read_b64_tr_b16 v[132:133], v116 offset:18432
  v_mfma_f32_32x32x16_bf16 v[80:95], v[144:147], a[144:147], v[80:95]
  ds_read_b64_tr_b16 v[134:135], v116 offset:18944
  v_and_b32 v5, 1, v1
  s_waitcnt lgkmcnt(8)
  v_mfma_f32_16x16x32_bf16 v[108:111], v[112:115], v[148:151], v[108:111]
  ds_read_b64_tr_b16 v[136:137], v116 offset:20480
  v_mfma_f32_32x32x16_bf16 v[80:95], v[148:151], a[148:151], v[80:95]
  ds_read_b64_tr_b16 v[138:139], v116 offset:20992
  v_lshlrev_b32 v5, 4, v5
  s_waitcnt lgkmcnt(8)
  v_mfma_f32_16x16x32_bf16 v[108:111], v[112:115], v[152:155], v[108:111]
  ds_read_b64_tr_b16 v[140:141], v116 offset:22528
  v_mfma_f32_32x32x16_bf16 v[80:95], v[152:155], a[152:155], v[80:95]
  ds_read_b64_tr_b16 v[142:143], v116 offset:23040
  v_lshl_add_u32 v15, v4, 7, v5
  s_waitcnt lgkmcnt(8)
  v_mfma_f32_16x16x32_bf16 v[108:111], v[112:115], v[156:159], v[108:111]
  ds_read_b64_tr_b16 v[144:145], v116 offset:24576
  v_mfma_f32_32x32x16_bf16 v[80:95], v[156:159], a[156:159], v[80:95]
  ds_read_b64_tr_b16 v[146:147], v116 offset:25088
  v_and_b32 v4, 1, v4
  s_waitcnt lgkmcnt(8)
  v_mfma_f32_16x16x32_bf16 v[108:111], v[112:115], v[128:131], v[108:111]
  ds_read_b64_tr_b16 v[148:149], v116 offset:26624
  v_mfma_f32_32x32x16_bf16 v[80:95], v[128:131], a[160:163], v[80:95]
  ds_read_b64_tr_b16 v[150:151], v116 offset:27136
  v_lshl_add_u32 v13, v4, 3, v5
  s_waitcnt lgkmcnt(8)
  v_mfma_f32_16x16x32_bf16 v[108:111], v[112:115], v[132:135], v[108:111]
  ds_read_b64_tr_b16 v[152:153], v116 offset:28672
  v_mfma_f32_32x32x16_bf16 v[80:95], v[132:135], a[164:167], v[80:95]
  ds_read_b64_tr_b16 v[154:155], v116 offset:29184
  v_lshrrev_b32 v4, 4, v1
  s_waitcnt lgkmcnt(8)
  v_mfma_f32_16x16x32_bf16 v[108:111], v[112:115], v[136:139], v[108:111]
  ds_read_b64_tr_b16 v[156:157], v116 offset:30720
  v_mfma_f32_32x32x16_bf16 v[80:95], v[136:139], a[168:171], v[80:95]
  ds_read_b64_tr_b16 v[158:159], v116 offset:31232
  v_lshl_add_u32 v13, v4, 2, v13
  s_waitcnt lgkmcnt(8)
  v_mfma_f32_16x16x32_bf16 v[108:111], v[112:115], v[140:143], v[108:111]
  ds_read_b64_tr_b16 v[128:129], v116 offset:32768
  v_mfma_f32_32x32x16_bf16 v[80:95], v[140:143], a[172:175], v[80:95]
  ds_read_b64_tr_b16 v[130:131], v116 offset:33280
  s_and_b32 s59, s40, 1
  v_bfe_u32 v4, v1, 4, 1
  s_waitcnt lgkmcnt(8)
  v_mfma_f32_16x16x32_bf16 v[108:111], v[112:115], v[144:147], v[108:111]
  ds_read_b64_tr_b16 v[132:133], v116 offset:34816
  v_mfma_f32_32x32x16_bf16 v[80:95], v[144:147], a[176:179], v[80:95]
  ds_read_b64_tr_b16 v[134:135], v116 offset:35328
  v_lshlrev_b32 v4, 5, v4
  v_and_b32 v5, 1, v1
  s_waitcnt lgkmcnt(8)
  v_mfma_f32_16x16x32_bf16 v[108:111], v[112:115], v[148:151], v[108:111]
  ds_read_b64_tr_b16 v[136:137], v116 offset:36864
  v_mfma_f32_32x32x16_bf16 v[80:95], v[148:151], a[180:183], v[80:95]
  ds_read_b64_tr_b16 v[138:139], v116 offset:37376
  v_lshl_add_u32 v4, v5, 4, v4
  v_bfe_u32 v5, v1, 1, 1
  s_waitcnt lgkmcnt(8)
  v_mfma_f32_16x16x32_bf16 v[108:111], v[112:115], v[152:155], v[108:111]
  ds_read_b64_tr_b16 v[140:141], v116 offset:38912
  v_mfma_f32_32x32x16_bf16 v[80:95], v[152:155], a[184:187], v[80:95]
  ds_read_b64_tr_b16 v[142:143], v116 offset:39424
  s_add_u32 m0, s19, 0
  s_nop 0
  buffer_load_dwordx4 v12, s[20:23], s18 offen lds
  s_add_u32 s18, s18, 7168
  s_add_u32 m0, s19, 4096
  s_nop 0
  buffer_load_dwordx4 v12, s[20:23], s18 offen lds
  s_add_u32 s18, s18, 7168
  v_lshl_add_u32 v4, v5, 3, v4
  v_add_u32 v4, s19, v4
  s_waitcnt lgkmcnt(8)
  v_mfma_f32_16x16x32_bf16 v[108:111], v[112:115], v[156:159], v[108:111]
  ds_read_b64_tr_b16 v[144:145], v116 offset:40960
  v_mfma_f32_32x32x16_bf16 v[80:95], v[156:159], a[188:191], v[80:95]
  ds_read_b64_tr_b16 v[146:147], v116 offset:41472
  s_add_u32 m0, s19, 8192
  s_nop 0
  buffer_load_dwordx4 v12, s[20:23], s18 offen lds
  s_add_u32 s18, s18, 7168
  s_add_u32 m0, s19, 12288
  s_nop 0
  buffer_load_dwordx4 v12, s[20:23], s18 offen lds
  s_add_u32 s18, s18, 7168
  v_bfe_u32 v5, v1, 2, 2
  v_lshrrev_b32 v6, 5, v1
  s_waitcnt lgkmcnt(8)
  v_mfma_f32_16x16x32_bf16 v[108:111], v[112:115], v[128:131], v[108:111]
  ds_read_b64_tr_b16 v[148:149], v116 offset:43008
  v_mfma_f32_32x32x16_bf16 v[80:95], v[128:131], a[192:195], v[80:95]
  ds_read_b64_tr_b16 v[150:151], v116 offset:43520
  s_add_u32 m0, s19, 16384
  s_nop 0
  buffer_load_dwordx4 v12, s[20:23], s18 offen lds
  s_add_u32 s18, s18, 7168
  s_add_u32 m0, s19, 20480
  s_nop 0
  buffer_load_dwordx4 v12, s[20:23], s18 offen lds
  s_add_u32 s18, s18, 7168
  v_lshl_add_u32 v64, v6, 2, v5
  v_lshl_add_u32 v64, v64, 7, v4
  s_waitcnt lgkmcnt(8)
  v_mfma_f32_16x16x32_bf16 v[108:111], v[112:115], v[132:135], v[108:111]
  ds_read_b64_tr_b16 v[152:153], v116 offset:45056
  v_mfma_f32_32x32x16_bf16 v[80:95], v[132:135], a[196:199], v[80:95]
  ds_read_b64_tr_b16 v[154:155], v116 offset:45568
  s_add_u32 m0, s19, 24576
  s_nop 0
  buffer_load_dwordx4 v12, s[20:23], s18 offen lds
  s_add_u32 s18, s18, 7168
  s_add_u32 m0, s19, 28672
  s_nop 0
  buffer_load_dwordx4 v12, s[20:23], s18 offen lds
  s_add_u32 s18, s18, 7168
  v_bfe_u32 v5, v1, 3, 1
  v_xor_b32 v5, s59, v5
  s_waitcnt lgkmcnt(8)
  v_mfma_f32_16x16x32_bf16 v[108:111], v[112:115], v[136:139], v[108:111]
  ds_read_b64_tr_b16 v[156:157], v116 offset:47104
  v_mfma_f32_32x32x16_bf16 v[80:95], v[136:139], a[200:203], v[80:95]
  ds_read_b64_tr_b16 v[158:159], v116 offset:47616
  s_add_u32 m0, s19, 32768
  s_nop 0
  buffer_load_dwordx4 v12, s[20:23], s18 offen lds
  s_add_u32 s18, s18, 7168
  s_add_u32 m0, s19, 36864
  s_nop 0
  buffer_load_dwordx4 v12, s[20:23], s18 offen lds
  s_add_u32 s18, s18, 7168
  v_lshl_add_u32 v64, v5, 6, v64
  v_xor_b32 v65, 64, v64
  s_waitcnt lgkmcnt(8)
  v_mfma_f32_16x16x32_bf16 v[108:111], v[112:115], v[140:143], v[108:111]
  ds_read_b64_tr_b16 v[128:129], v116 offset:49152
  v_mfma_f32_32x32x16_bf16 v[80:95], v[140:143], a[204:207], v[80:95]
  ds_read_b64_tr_b16 v[130:131], v116 offset:49664
  s_add_u32 m0, s19, 40960
  s_nop 0
  buffer_load_dwordx4 v12, s[20:23], s18 offen lds
  s_add_u32 s18, s18, 7168
  s_add_u32 m0, s19, 45056
  s_nop 0
  buffer_load_dwordx4 v12, s[20:23], s18 offen lds
  s_add_u32 s18, s18, 7168
  v_bfe_u32 v5, v1, 2, 1
  v_lshl_add_u32 v66, v6, 1, v5
  s_waitcnt lgkmcnt(8)
  v_mfma_f32_16x16x32_bf16 v[108:111], v[112:115], v[144:147], v[108:111]
  ds_read_b64_tr_b16 v[132:133], v116 offset:51200
  v_mfma_f32_32x32x16_bf16 v[80:95], v[144:147], a[208:211], v[80:95]
  ds_read_b64_tr_b16 v[134:135], v116 offset:51712
  s_add_u32 m0, s19, 49152
  s_nop 0
  buffer_load_dwordx4 v12, s[20:23], s18 offen lds
  s_add_u32 s18, s18, 7168
  s_add_u32 m0, s19, 53248
  s_nop 0
  buffer_load_dwordx4 v12, s[20:23], s18 offen lds
  s_add_u32 s18, s18, 7168
  v_lshl_add_u32 v66, v66, 7, v4
  v_xor_b32 v5, s59, v6
  s_waitcnt lgkmcnt(8)
  v_mfma_f32_16x16x32_bf16 v[108:111], v[112:115], v[148:151], v[108:111]
  ds_read_b64_tr_b16 v[136:137], v116 offset:53248
  v_mfma_f32_32x32x16_bf16 v[80:95], v[148:151], a[212:215], v[80:95]
  ds_read_b64_tr_b16 v[138:139], v116 offset:53760
  v_lshl_add_u32 v66, v5, 6, v66
  v_xor_b32 v67, 64, v66
  s_waitcnt lgkmcnt(8)
  v_mfma_f32_16x16x32_bf16 v[108:111], v[112:115], v[152:155], v[108:111]
  ds_read_b64_tr_b16 v[140:141], v116 offset:55296
  v_mfma_f32_32x32x16_bf16 v[80:95], v[152:155], a[216:219], v[80:95]
  ds_read_b64_tr_b16 v[142:143], v116 offset:55808
  v_mul_u32_u24 v6, 3072, v6
  v_add_u32 v68, v6, v64
  s_waitcnt lgkmcnt(8)
  v_mfma_f32_16x16x32_bf16 v[108:111], v[112:115], v[156:159], v[108:111]
  v_mfma_f32_32x32x16_bf16 v[80:95], v[156:159], a[220:223], v[80:95]
  v_xor_b32 v69, 64, v68
  s_waitcnt lgkmcnt(6)
  v_mfma_f32_16x16x32_bf16 v[108:111], v[112:115], v[128:131], v[108:111]
  v_mfma_f32_32x32x16_bf16 v[80:95], v[128:131], a[224:227], v[80:95]
  s_waitcnt lgkmcnt(4)
  v_mfma_f32_16x16x32_bf16 v[108:111], v[112:115], v[132:135], v[108:111]
  v_mfma_f32_32x32x16_bf16 v[80:95], v[132:135], a[228:231], v[80:95]
  s_waitcnt lgkmcnt(2)
  v_mfma_f32_16x16x32_bf16 v[108:111], v[112:115], v[136:139], v[108:111]
  v_mfma_f32_32x32x16_bf16 v[80:95], v[136:139], a[232:235], v[80:95]
  s_waitcnt lgkmcnt(0)
  v_mfma_f32_16x16x32_bf16 v[108:111], v[112:115], v[140:143], v[108:111]
  v_mfma_f32_32x32x16_bf16 v[80:95], v[140:143], a[236:239], v[80:95]
  s_branch L_ov2
  .p2align 12
L_pg2:
  s_branch L_bk1
L_ov2:
  buffer_load_dwordx4 v[24:27], v15, s[12:15], s55 offen sc1
  buffer_load_dwordx4 v[28:31], v15, s[12:15], s57 offen sc1
  s_nop 4
  v_cvt_pk_bf16_f32 v109, v108, v108
  v_lshlrev_b32 v109, 16, v109
  v_sub_f32 v109, v108, v109
  v_cvt_pk_bf16_f32 v200, v108, v109
  v_cvt_pk_bf16_f32 v201, v108, v109
  s_nop 1
  v_mfma_f32_32x32x16_bf16 v[80:95], v[200:203], v[160:163], v[80:95]
  s_lshl_b32 s58, s41, 11
  s_add_u32 s58, s58, 2097152
  s_lshl_b32 s59, s41, 6
  s_add_u32 s59, s59, 262144
  s_nop 7
  v_pk_fma_f32 v[80:81], v[80:81], v[168:169], v[170:171] op_sel_hi:[1,0,0]
  v_pk_fma_f32 v[82:83], v[82:83], v[168:169], v[170:171] op_sel_hi:[1,0,0]
  v_pk_fma_f32 v[84:85], v[84:85], v[168:169], v[170:171] op_sel_hi:[1,0,0]
  v_pk_fma_f32 v[86:87], v[86:87], v[168:169], v[170:171] op_sel_hi:[1,0,0]
  v_pk_fma_f32 v[88:89], v[88:89], v[168:169], v[170:171] op_sel_hi:[1,0,0]
  v_pk_fma_f32 v[90:91], v[90:91], v[168:169], v[170:171] op_sel_hi:[1,0,0]
  v_pk_fma_f32 v[92:93], v[92:93], v[168:169], v[170:171] op_sel_hi:[1,0,0]
  v_pk_fma_f32 v[94:95], v[94:95], v[168:169], v[170:171] op_sel_hi:[1,0,0]
  v_pk_mul_f32 v[176:177], v[80:81], v[172:173] op_sel_hi:[1,0]
  v_pk_mul_f32 v[178:179], v[82:83], v[172:173] op_sel_hi:[1,0]
  v_pk_mul_f32 v[180:181], v[84:85], v[172:173] op_sel_hi:[1,0]
  v_pk_mul_f32 v[182:183], v[86:87], v[172:173] op_sel_hi:[1,0]
  v_pk_mul_f32 v[184:185], v[88:89], v[172:173] op_sel_hi:[1,0]
  v_pk_mul_f32 v[186:187], v[90:91], v[172:173] op_sel_hi:[1,0]
  v_pk_mul_f32 v[188:189], v[92:93], v[172:173] op_sel_hi:[1,0]
  v_pk_mul_f32 v[190:191], v[94:95], v[172:173] op_sel_hi:[1,0]
  v_exp_f32_e64 v176, v176 clamp
  v_max_f32 v80, v80, v170
  v_exp_f32_e64 v177, v177 clamp
  v_max_f32 v81, v81, v170
  v_exp_f32_e64 v178, v178 clamp
  v_max_f32 v82, v82, v170
  v_exp_f32_e64 v179, v179 clamp
  v_max_f32 v83, v83, v170
  v_exp_f32_e64 v180, v180 clamp
  v_max_f32 v84, v84, v170
  v_exp_f32_e64 v181, v181 clamp
  v_max_f32 v85, v85, v170
  v_exp_f32_e64 v182, v182 clamp
  v_max_f32 v86, v86, v170
  v_exp_f32_e64 v183, v183 clamp
  v_max_f32 v87, v87, v170
  v_exp_f32_e64 v184, v184 clamp
  v_max_f32 v88, v88, v170
  v_exp_f32_e64 v185, v185 clamp
  v_max_f32 v89, v89, v170
  v_exp_f32_e64 v186, v186 clamp
  v_max_f32 v90, v90, v170
  v_exp_f32_e64 v187, v187 clamp
  v_max_f32 v91, v91, v170
  v_exp_f32_e64 v188, v188 clamp
  v_max_f32 v92, v92, v170
  v_exp_f32_e64 v189, v189 clamp
  v_max_f32 v93, v93, v170
  v_exp_f32_e64 v190, v190 clamp
  v_max_f32 v94, v94, v170
  v_exp_f32_e64 v191, v191 clamp
  v_max_f32 v95, v95, v170
  v_pk_add_f32 v[80:81], v[80:81], v[176:177]
  v_pk_add_f32 v[82:83], v[82:83], v[178:179]
  v_pk_add_f32 v[84:85], v[84:85], v[180:181]
  v_pk_add_f32 v[86:87], v[86:87], v[182:183]
  v_pk_add_f32 v[88:89], v[88:89], v[184:185]
  v_pk_add_f32 v[90:91], v[90:91], v[186:187]
  v_pk_add_f32 v[92:93], v[92:93], v[188:189]
  v_pk_add_f32 v[94:95], v[94:95], v[190:191]
  v_cvt_pk_bf16_f32 v224, v80, v81
  v_cvt_pk_bf16_f32 v225, v82, v83
  v_cvt_pk_bf16_f32 v226, v84, v85
  v_cvt_pk_bf16_f32 v227, v86, v87
  v_cvt_pk_bf16_f32 v228, v88, v89
  v_cvt_pk_bf16_f32 v229, v90, v91
  v_cvt_pk_bf16_f32 v230, v92, v93
  v_cvt_pk_bf16_f32 v231, v94, v95
  s_mov_b32 exec_lo, 0
  v_mov_b32 v230, 0
  v_mov_b32 v231, 0
  s_mov_b64 exec, -1
  buffer_store_dwordx4 v[224:227], v2, s[12:15], s58 offen sc1
  buffer_store_dwordx4 v[228:231], v2, s[12:15], s58 offen offset:1024 sc1
  s_mov_b32 s48, 262144
  s_mov_b32 s49, 0x0c0c0400
  v_mov_b32 v7, 0
L_red:
  s_waitcnt vmcnt(3)
  v_perm_b32 v3, v25, v24, s49
  v_perm_b32 v4, v27, v26, s49
  s_waitcnt vmcnt(2)
  v_perm_b32 v5, v29, v28, s49
  v_perm_b32 v6, v31, v30, s49
  v_lshl_or_b32 v3, v4, 16, v3
  v_lshl_or_b32 v5, v6, 16, v5
  v_xor_b32 v3, s1, v3
  v_xor_b32 v5, s1, v5
  v_or_b32 v3, v3, v5
  v_cmp_ne_u32 vcc, 0, v3
  s_cbranch_vccz L_redx
  buffer_load_dwordx4 v[24:27], v15, s[12:15], s55 offen sc1
  buffer_load_dwordx4 v[28:31], v15, s[12:15], s57 offen sc1
  s_waitcnt vmcnt(2)
  s_mov_b64 exec, 1
  v_mov_b32 v3, s1
  buffer_store_dword v3, v7, s[12:15], s59 offen sc1
  s_mov_b64 exec, -1
  v_bfrev_b32 v7, 8
  s_sub_u32 s48, s48, 1
  s_waitcnt vmcnt(1)
  s_cbranch_scc0 L_red
L_redx:
  v_pk_add_f32 v[24:25], v[24:25], v[28:29]
  v_pk_add_f32 v[26:27], v[26:27], v[30:31]
  s_nop 0
  v_permlane32_swap_b32 v24, v25
  v_permlane32_swap_b32 v26, v27
  v_add_f32 v24, v24, v25
  v_add_f32 v26, v26, v27
  s_nop 1
  v_permlane16_swap_b32 v24, v26
  v_add_f32 v24, v24, v26
  s_nop 1
  v_add_f32_dpp v24, v24, v24 row_ror:8 row_mask:0xf bank_mask:0xf
  s_nop 1
  v_add_f32_dpp v24, v24, v24 row_ror:4 row_mask:0xf bank_mask:0xf
  v_mov_b32 v25, v24
  s_nop 1
  v_permlane32_swap_b32 v24, v25
  v_cvt_pk_bf16_f32 v24, v24, v25
  v_max_u32 v24, 1, v24
  s_mov_b64 exec, 0x000f000f
  buffer_store_dword v24, v13, s[12:15], s56 offen sc1
  s_mov_b64 exec, -1
  s_waitcnt vmcnt(1)
  s_mov_b64 exec, 1
  v_mov_b32 v3, s1
  buffer_store_dword v3, v7, s[12:15], s59 offen sc1
  s_mov_b64 exec, -1
  s_cmp_ge_u32 s47, 28
  s_cbranch_scc1 L_fin0
  s_lshr_b32 s48, s40, 1
  s_lshl_b32 s100, s43, 1
  s_add_u32 s100, s100, s48
  v_and_b32 v4, 31, v1
  v_mul_u32_u24 v4, 896, v4
  v_lshrrev_b32 v5, 5, v1
  v_lshl_add_u32 v14, v5, 4, v4
  s_mul_i32 s101, s100, 28672
  s_lshl_b32 s48, s44, 7
  s_add_u32 s101, s101, s48
  s_and_b32 s48, s40, 1
  s_lshl_b32 s48, s48, 6
  s_add_u32 s101, s101, s48
  s_lshl_b32 s56, s40, 13
  s_add_u32 s59, s56, 2097152
  s_add_u32 s56, s56, 1048576
  s_add_u32 s55, s56, 4096
  s_lshl_b32 s57, s100, 15
  s_add_u32 s57, s57, s59
  s_xor_b32 s58, s100, 1
  s_lshl_b32 s58, s58, 15
  s_add_u32 s58, s58, s59
  v_add_u32 v13, 4096, v2
  buffer_load_dwordx4 v[16:19], v14, s[4:7], s101 offen
  buffer_load_dwordx4 v[20:23], v14, s[4:7], s101 offen offset:32
  v_lshrrev_b32 v4, 3, v1
  v_mul_u32_u24 v76, 896, v4
  v_bfe_u32 v4, v1, 4, 1
  v_lshlrev_b32 v4, 2, v4
  v_and_b32 v5, 7, v1
  v_xor_b32 v4, v4, v5
  v_lshl_add_u32 v76, v4, 4, v76
  v_add_u32 v77, 6144, v76
  s_mul_i32 s17, s40, 401408
  s_lshl_b32 s48, s44, 7
  s_add_u32 s17, s17, s48
  s_add_u32 s18, s17, 401408
  s_mul_i32 s16, s0, 57344
  s_add_u32 s16, s16, s17
  s_mul_i32 s19, s40, 12288
  s_add_u32 s19, s19, 114688
  s_and_b32 s49, s40, 1
  v_bfe_u32 v4, v1, 4, 1
  v_lshlrev_b32 v4, 5, v4
  v_and_b32 v5, 1, v1
  v_lshl_add_u32 v4, v5, 4, v4
  v_bfe_u32 v5, v1, 1, 1
  v_lshl_add_u32 v4, v5, 3, v4
  v_add_u32 v4, s19, v4
  v_bfe_u32 v5, v1, 2, 2
  v_lshrrev_b32 v6, 5, v1
  v_lshl_add_u32 v78, v6, 3, v5
  v_lshl_add_u32 v78, v78, 7, v4
  v_bfe_u32 v5, v1, 3, 1
  v_xor_b32 v5, s49, v5
  v_lshl_add_u32 v78, v5, 6, v78
  v_xor_b32 v79, 64, v78
  s_xor_b32 s48, s40, 1
  s_mul_i32 s48, s48, 12288
  s_add_u32 s48, s48, 114688
  v_add_u32 v73, s48, v2
  s_xor_b32 s48, s40, 2
  s_mul_i32 s48, s48, 12288
  s_add_u32 s48, s48, 118784
  v_add_u32 v74, s48, v2
  s_xor_b32 s48, s40, 3
  s_mul_i32 s48, s48, 12288
  s_add_u32 s48, s48, 122880
  v_add_u32 v75, s48, v2
  v_add_u32 v72, s19, v2
  v_mov_b32 v63, 0
  v_mov_b32 v71, 0
  ds_read_b64_tr_b16 a[0:1], v64 offset:0
  ds_read_b64_tr_b16 a[2:3], v64 offset:4096
  ds_read_b64_tr_b16 a[4:5], v64 offset:8192
  ds_read_b64_tr_b16 a[6:7], v66 offset:12288
  ds_read_b64_tr_b16 a[8:9], v65 offset:0
  ds_read_b64_tr_b16 a[10:11], v65 offset:4096
  ds_read_b64_tr_b16 a[12:13], v65 offset:8192
  ds_read_b64_tr_b16 a[14:15], v67 offset:12288
  ds_read_b64_tr_b16 a[16:17], v68 offset:12800
  ds_read_b64_tr_b16 a[18:19], v68 offset:16896
  ds_read_b64_tr_b16 a[20:21], v68 offset:20992
  ds_read_b64_tr_b16 a[22:23], v66 offset:25088
  ds_read_b64_tr_b16 a[24:25], v69 offset:12800
  ds_read_b64_tr_b16 a[26:27], v69 offset:16896
  ds_read_b64_tr_b16 a[28:29], v69 offset:20992
  ds_read_b64_tr_b16 a[30:31], v67 offset:25088
  ds_read_b64_tr_b16 a[32:33], v64 offset:28672
  ds_read_b64_tr_b16 a[34:35], v64 offset:32768
  ds_read_b64_tr_b16 a[36:37], v64 offset:36864
  ds_read_b64_tr_b16 a[38:39], v66 offset:40960
  ds_read_b64_tr_b16 a[40:41], v65 offset:28672
  ds_read_b64_tr_b16 a[42:43], v65 offset:32768
  ds_read_b64_tr_b16 a[44:45], v65 offset:36864
  ds_read_b64_tr_b16 a[46:47], v67 offset:40960
  ds_read_b64_tr_b16 a[48:49], v68 offset:41472
  ds_read_b64_tr_b16 a[50:51], v68 offset:45568
  ds_read_b64_tr_b16 a[52:53], v68 offset:49664
  ds_read_b64_tr_b16 a[54:55], v66 offset:53760
  ds_read_b64_tr_b16 a[56:57], v69 offset:41472
  ds_read_b64_tr_b16 a[58:59], v69 offset:45568
  ds_read_b64_tr_b16 a[60:61], v69 offset:49664
  ds_read_b64_tr_b16 a[62:63], v67 offset:53760
  s_waitcnt lgkmcnt(0)
  s_barrier
  v_and_b32 v4, 3, v1
  v_bfe_u32 v5, v1, 2, 1
  v_lshl_add_u32 v4, v5, 4, v4
  v_lshlrev_b32 v4, 6, v4
  s_lshl_b32 s59, s43, 11
  s_lshl_b32 s48, s40, 8
  s_add_u32 s59, s59, s48
  s_add_u32 s59, s59, 262144
  s_mov_b32 s48, 262144
L_poll_pq:
  buffer_load_dword v5, v4, s[12:15], s59 offen sc1
  s_sub_u32 s48, s48, 1
  s_waitcnt vmcnt(0)
  v_cmp_eq_u32 vcc, s1, v5
  s_cbranch_scc1 L_pollx_pq
  s_andn2_b32 s49, 0xff, vcc_lo
  s_cbranch_scc1 L_poll_pq
L_pollx_pq:
  buffer_load_dwordx4 v[192:195], v2, s[12:15], s57 offen offset:0 sc1
  buffer_load_dwordx4 v[196:199], v2, s[12:15], s57 offen offset:1024 sc1
  buffer_load_dwordx4 v[200:203], v2, s[12:15], s58 offen offset:0 sc1
  buffer_load_dwordx4 v[204:207], v2, s[12:15], s58 offen offset:1024 sc1
  buffer_load_dwordx4 v[208:211], v2, s[12:15], s57 offen offset:2048 sc1
  buffer_load_dwordx4 v[212:215], v2, s[12:15], s57 offen offset:3072 sc1
  buffer_load_dwordx4 v[216:219], v2, s[12:15], s58 offen offset:2048 sc1
  buffer_load_dwordx4 v[220:223], v2, s[12:15], s58 offen offset:3072 sc1
  buffer_load_dwordx4 v[224:227], v13, s[12:15], s57 offen offset:0 sc1
  buffer_load_dwordx4 v[228:231], v13, s[12:15], s57 offen offset:1024 sc1
  buffer_load_dwordx4 v[232:235], v13, s[12:15], s58 offen offset:0 sc1
  buffer_load_dwordx4 v[236:239], v13, s[12:15], s58 offen offset:1024 sc1
  buffer_load_dwordx4 v[240:243], v13, s[12:15], s57 offen offset:2048 sc1
  buffer_load_dwordx4 v[244:247], v13, s[12:15], s57 offen offset:3072 sc1
  buffer_load_dwordx4 v[248:251], v13, s[12:15], s58 offen offset:2048 sc1
  buffer_load_dwordx4 v[252:255], v13, s[12:15], s58 offen offset:3072 sc1
  buffer_load_dwordx4 v[80:83], v2, s[12:15], s56 offen offset:0 sc1
  buffer_load_dwordx4 v[84:87], v2, s[12:15], s56 offen offset:1024 sc1
  buffer_load_dwordx4 v[88:91], v2, s[12:15], s56 offen offset:2048 sc1
  buffer_load_dwordx4 v[92:95], v2, s[12:15], s56 offen offset:3072 sc1
  buffer_load_dwordx4 v[96:99], v2, s[12:15], s55 offen offset:0 sc1
  buffer_load_dwordx4 v[100:103], v2, s[12:15], s55 offen offset:1024 sc1
  buffer_load_dwordx4 v[104:107], v2, s[12:15], s55 offen offset:2048 sc1
  buffer_load_dwordx4 v[108:111], v2, s[12:15], s55 offen offset:3072 sc1
  v_lshlrev_b32 v128, 16, v16
  v_and_b32 v129, 0xffff0000, v16
  v_lshlrev_b32 v130, 16, v17
  v_and_b32 v131, 0xffff0000, v17
  v_lshlrev_b32 v132, 16, v18
  v_and_b32 v133, 0xffff0000, v18
  v_lshlrev_b32 v134, 16, v19
  v_and_b32 v135, 0xffff0000, v19
  v_lshlrev_b32 v136, 16, v20
  v_and_b32 v137, 0xffff0000, v20
  v_lshlrev_b32 v138, 16, v21
  v_and_b32 v139, 0xffff0000, v21
  v_lshlrev_b32 v140, 16, v22
  v_and_b32 v141, 0xffff0000, v22
  v_lshlrev_b32 v142, 16, v23
  v_and_b32 v143, 0xffff0000, v23
  s_mov_b32 s48, 262144
L_kvf:
  s_waitcnt vmcnt(7)
  v_min3_u32 v3, v80, v81, v82
  s_waitcnt vmcnt(6)
  v_min3_u32 v3, v3, v83, v84
  v_min3_u32 v3, v3, v85, v86
  s_waitcnt vmcnt(5)
  v_min3_u32 v3, v3, v87, v88
  v_min3_u32 v3, v3, v89, v90
  s_waitcnt vmcnt(4)
  v_min3_u32 v3, v3, v91, v92
  v_min3_u32 v3, v3, v93, v94
  s_waitcnt vmcnt(3)
  v_min3_u32 v3, v3, v95, v96
  v_min3_u32 v3, v3, v97, v98
  s_waitcnt vmcnt(2)
  v_min3_u32 v3, v3, v99, v100
  v_min3_u32 v3, v3, v101, v102
  s_waitcnt vmcnt(1)
  v_min3_u32 v3, v3, v103, v104
  v_min3_u32 v3, v3, v105, v106
  s_waitcnt vmcnt(0)
  v_min3_u32 v3, v3, v107, v108
  v_min3_u32 v3, v3, v109, v110
  v_min_u32 v3, v3, v111
  v_cmp_eq_u32 vcc, 0, v3
  s_cbranch_vccz L_kvfx
  buffer_load_dwordx4 v[80:83], v2, s[12:15], s56 offen offset:0 sc1
  buffer_load_dwordx4 v[84:87], v2, s[12:15], s56 offen offset:1024 sc1
  buffer_load_dwordx4 v[88:91], v2, s[12:15], s56 offen offset:2048 sc1
  buffer_load_dwordx4 v[92:95], v2, s[12:15], s56 offen offset:3072 sc1
  buffer_load_dwordx4 v[96:99], v2, s[12:15], s55 offen offset:0 sc1
  buffer_load_dwordx4 v[100:103], v2, s[12:15], s55 offen offset:1024 sc1
  buffer_load_dwordx4 v[104:107], v2, s[12:15], s55 offen offset:2048 sc1
  buffer_load_dwordx4 v[108:111], v2, s[12:15], s55 offen offset:3072 sc1
  s_sub_u32 s48, s48, 1
  s_waitcnt vmcnt(0)
  s_cbranch_scc0 L_kvf
L_kvfx:
  v_mfma_f32_32x32x16_bf16 v[24:39], v[80:83], v[192:195], 0
  v_mfma_f32_32x32x16_bf16 v[24:39], v[84:87], v[196:199], v[24:39]
  v_mfma_f32_32x32x16_bf16 v[40:55], v[80:83], v[200:203], 0
  v_mfma_f32_32x32x16_bf16 v[40:55], v[84:87], v[204:207], v[40:55]
  s_nop 9
  v_add_f32 v4, 0x358637bd, v39
  v_rcp_f32 v4, v4
  s_nop 0
  v_mul_f32 v24, v24, v4
  v_mul_f32 v25, v25, v4
  v_mul_f32 v26, v26, v4
  v_mul_f32 v27, v27, v4
  v_mul_f32 v28, v28, v4
  v_mul_f32 v29, v29, v4
  v_mul_f32 v30, v30, v4
  v_mul_f32 v31, v31, v4
  v_mul_f32 v32, v32, v4
  v_mul_f32 v33, v33, v4
  v_mul_f32 v34, v34, v4
  v_mul_f32 v35, v35, v4
  v_mul_f32 v36, v36, v4
  v_mul_f32 v37, v37, v4
  v_cvt_pk_bf16_f32 v56, v24, v25
  v_cvt_pk_bf16_f32 v57, v26, v27
  v_cvt_pk_bf16_f32 v58, v28, v29
  v_cvt_pk_bf16_f32 v59, v30, v31
  v_cvt_pk_bf16_f32 v60, v32, v33
  v_cvt_pk_bf16_f32 v61, v34, v35
  v_cvt_pk_bf16_f32 v62, v36, v37
  v_mfma_f32_32x32x16_bf16 v[128:143], a[0:3], v[56:59], v[128:143]
  v_add_f32 v4, 0x358637bd, v55
  v_rcp_f32 v4, v4
  s_nop 0
  v_mul_f32 v40, v40, v4
  v_mul_f32 v41, v41, v4
  s_add_u32 m0, s52, 57344
  s_nop 0
  buffer_load_dwordx4 v124, s[28:31], s50 offen lds
  v_mfma_f32_32x32x16_bf16 v[144:159], a[8:11], v[56:59], 0
  v_mul_f32 v42, v42, v4
  v_mul_f32 v43, v43, v4
  v_mul_f32 v44, v44, v4
  v_mul_f32 v45, v45, v4
  v_mul_f32 v46, v46, v4
  v_mfma_f32_32x32x16_bf16 v[128:143], a[4:7], v[60:63], v[128:143]
  v_mul_f32 v47, v47, v4
  v_mul_f32 v48, v48, v4
  s_add_u32 m0, s52, 57344
  s_nop 0
  buffer_load_dwordx4 v125, s[28:31], s50 offen offset:1024 lds
  s_add_u32 s50, s50, 229376
  s_cmp_eq_u32 s50, s54
  s_cselect_b32 s50, s53, s50
  v_mul_f32 v49, v49, v4
  v_mfma_f32_32x32x16_bf16 v[144:159], a[12:15], v[60:63], v[144:159]
  v_mul_f32 v50, v50, v4
  v_mul_f32 v51, v51, v4
  v_mul_f32 v52, v52, v4
  v_mul_f32 v53, v53, v4
  v_mfma_f32_32x32x16_bf16 v[24:39], v[88:91], v[208:211], 0
  v_cvt_pk_bf16_f32 v64, v40, v41
  v_cvt_pk_bf16_f32 v65, v42, v43
  s_add_u32 m0, s52, 65536
  s_nop 0
  buffer_load_dwordx4 v124, s[28:31], s50 offen lds
  v_cvt_pk_bf16_f32 v66, v44, v45
  v_mfma_f32_32x32x16_bf16 v[24:39], v[92:95], v[212:215], v[24:39]
  v_cvt_pk_bf16_f32 v67, v46, v47
  v_cvt_pk_bf16_f32 v68, v48, v49
  v_cvt_pk_bf16_f32 v69, v50, v51
  v_cvt_pk_bf16_f32 v70, v52, v53
  v_mfma_f32_32x32x16_bf16 v[160:175], a[0:3], v[64:67], 0
  s_nop 6
  v_add_f32 v4, 0x358637bd, v39
  v_rcp_f32 v4, v4
  s_nop 0
  v_mul_f32 v24, v24, v4
  v_mul_f32 v25, v25, v4
  s_add_u32 m0, s52, 65536
  s_nop 0
  buffer_load_dwordx4 v125, s[28:31], s50 offen offset:1024 lds
  s_add_u32 s50, s50, 229376
  s_cmp_eq_u32 s50, s54
  s_cselect_b32 s50, s53, s50
  v_mfma_f32_32x32x16_bf16 v[176:191], a[8:11], v[64:67], 0
  v_mul_f32 v26, v26, v4
  v_mul_f32 v27, v27, v4
  v_mul_f32 v28, v28, v4
  v_mul_f32 v29, v29, v4
  v_mul_f32 v30, v30, v4
  v_mfma_f32_32x32x16_bf16 v[160:175], a[4:7], v[68:71], v[160:175]
  v_mul_f32 v31, v31, v4
  v_mul_f32 v32, v32, v4
  s_add_u32 m0, s52, 73728
  s_nop 0
  buffer_load_dwordx4 v124, s[28:31], s50 offen lds
  v_mul_f32 v33, v33, v4
  v_mfma_f32_32x32x16_bf16 v[176:191], a[12:15], v[68:71], v[176:191]
  v_mul_f32 v34, v34, v4
  v_mul_f32 v35, v35, v4
  v_mul_f32 v36, v36, v4
  v_mul_f32 v37, v37, v4
  v_mfma_f32_32x32x16_bf16 v[40:55], v[88:91], v[216:219], 0
  v_cvt_pk_bf16_f32 v56, v24, v25
  v_cvt_pk_bf16_f32 v57, v26, v27
  s_add_u32 m0, s52, 73728
  s_nop 0
  buffer_load_dwordx4 v125, s[28:31], s50 offen offset:1024 lds
  s_add_u32 s50, s50, 229376
  s_cmp_eq_u32 s50, s54
  s_cselect_b32 s50, s53, s50
  v_cvt_pk_bf16_f32 v58, v28, v29
  v_mfma_f32_32x32x16_bf16 v[40:55], v[92:95], v[220:223], v[40:55]
  v_cvt_pk_bf16_f32 v59, v30, v31
  v_cvt_pk_bf16_f32 v60, v32, v33
  v_cvt_pk_bf16_f32 v61, v34, v35
  v_cvt_pk_bf16_f32 v62, v36, v37
  v_mfma_f32_32x32x16_bf16 v[128:143], a[16:19], v[56:59], v[128:143]
  s_nop 6
  v_add_f32 v4, 0x358637bd, v55
  v_rcp_f32 v4, v4
  s_nop 0
  v_mul_f32 v40, v40, v4
  v_mul_f32 v41, v41, v4
  s_add_u32 m0, s52, 81920
  s_nop 0
  buffer_load_dwordx4 v124, s[28:31], s50 offen lds
  v_mfma_f32_32x32x16_bf16 v[144:159], a[24:27], v[56:59], v[144:159]
  v_mul_f32 v42, v42, v4
  v_mul_f32 v43, v43, v4
  v_mul_f32 v44, v44, v4
  v_mul_f32 v45, v45, v4
  v_mul_f32 v46, v46, v4
  v_mfma_f32_32x32x16_bf16 v[128:143], a[20:23], v[60:63], v[128:143]
  v_mul_f32 v47, v47, v4
  v_mul_f32 v48, v48, v4
  s_add_u32 m0, s52, 81920
  s_nop 0
  buffer_load_dwordx4 v125, s[28:31], s50 offen offset:1024 lds
  s_add_u32 s50, s50, 229376
  s_cmp_eq_u32 s50, s54
  s_cselect_b32 s50, s53, s50
  v_mul_f32 v49, v49, v4
  v_mfma_f32_32x32x16_bf16 v[144:159], a[28:31], v[60:63], v[144:159]
  v_mul_f32 v50, v50, v4
  v_mul_f32 v51, v51, v4
  v_mul_f32 v52, v52, v4
  v_mul_f32 v53, v53, v4
  v_mfma_f32_32x32x16_bf16 v[24:39], v[96:99], v[224:227], 0
  v_cvt_pk_bf16_f32 v64, v40, v41
  v_cvt_pk_bf16_f32 v65, v42, v43
  s_add_u32 m0, s52, 90112
  s_nop 0
  buffer_load_dwordx4 v124, s[28:31], s50 offen lds
  v_cvt_pk_bf16_f32 v66, v44, v45
  v_mfma_f32_32x32x16_bf16 v[24:39], v[100:103], v[228:231], v[24:39]
  v_cvt_pk_bf16_f32 v67, v46, v47
  v_cvt_pk_bf16_f32 v68, v48, v49
  v_cvt_pk_bf16_f32 v69, v50, v51
  v_cvt_pk_bf16_f32 v70, v52, v53
  v_mfma_f32_32x32x16_bf16 v[160:175], a[16:19], v[64:67], v[160:175]
  s_nop 6
  v_add_f32 v4, 0x358637bd, v39
  v_rcp_f32 v4, v4
  s_nop 0
  v_mul_f32 v24, v24, v4
  v_mul_f32 v25, v25, v4
  s_add_u32 m0, s52, 90112
  s_nop 0
  buffer_load_dwordx4 v125, s[28:31], s50 offen offset:1024 lds
  s_add_u32 s50, s50, 229376
  s_cmp_eq_u32 s50, s54
  s_cselect_b32 s50, s53, s50
  v_mfma_f32_32x32x16_bf16 v[176:191], a[24:27], v[64:67], v[176:191]
  v_mul_f32 v26, v26, v4
  v_mul_f32 v27, v27, v4
  v_mul_f32 v28, v28, v4
  v_mul_f32 v29, v29, v4
  v_mul_f32 v30, v30, v4
  v_mfma_f32_32x32x16_bf16 v[160:175], a[20:23], v[68:71], v[160:175]
  v_mul_f32 v31, v31, v4
  v_mul_f32 v32, v32, v4
  s_add_u32 m0, s52, 98304
  s_nop 0
  buffer_load_dwordx4 v124, s[28:31], s50 offen lds
  v_mul_f32 v33, v33, v4
  v_mfma_f32_32x32x16_bf16 v[176:191], a[28:31], v[68:71], v[176:191]
  v_mul_f32 v34, v34, v4
  v_mul_f32 v35, v35, v4
  v_mul_f32 v36, v36, v4
  v_mul_f32 v37, v37, v4
  v_mfma_f32_32x32x16_bf16 v[40:55], v[96:99], v[232:235], 0
  v_cvt_pk_bf16_f32 v56, v24, v25
  v_cvt_pk_bf16_f32 v57, v26, v27
  s_add_u32 m0, s52, 98304
  s_nop 0
  buffer_load_dwordx4 v125, s[28:31], s50 offen offset:1024 lds
  s_add_u32 s50, s50, 229376
  s_cmp_eq_u32 s50, s54
  s_cselect_b32 s50, s53, s50
  v_cvt_pk_bf16_f32 v58, v28, v29
  v_mfma_f32_32x32x16_bf16 v[40:55], v[100:103], v[236:239], v[40:55]
  v_cvt_pk_bf16_f32 v59, v30, v31
  v_cvt_pk_bf16_f32 v60, v32, v33
  v_cvt_pk_bf16_f32 v61, v34, v35
  v_cvt_pk_bf16_f32 v62, v36, v37
  v_mfma_f32_32x32x16_bf16 v[128:143], a[32:35], v[56:59], v[128:143]
  s_nop 6
  v_add_f32 v4, 0x358637bd, v55
  v_rcp_f32 v4, v4
  s_nop 0
  v_mul_f32 v40, v40, v4
  v_mul_f32 v41, v41, v4
  s_add_u32 m0, s52, 106496
  s_nop 0
  buffer_load_dwordx4 v124, s[28:31], s50 offen lds
  v_mfma_f32_32x32x16_bf16 v[144:159], a[40:43], v[56:59], v[144:159]
  v_mul_f32 v42, v42, v4
  v_mul_f32 v43, v43, v4
  v_mul_f32 v44, v44, v4
  v_mul_f32 v45, v45, v4
  v_mul_f32 v46, v46, v4
  v_mfma_f32_32x32x16_bf16 v[128:143], a[36:39], v[60:63], v[128:143]
  v_mul_f32 v47, v47, v4
  v_mul_f32 v48, v48, v4
  s_add_u32 m0, s52, 106496
  s_nop 0
  buffer_load_dwordx4 v125, s[28:31], s50 offen offset:1024 lds
  s_add_u32 s50, s50, 229376
  s_cmp_eq_u32 s50, s54
  s_cselect_b32 s50, s53, s50
  v_mul_f32 v49, v49, v4
  v_mfma_f32_32x32x16_bf16 v[144:159], a[44:47], v[60:63], v[144:159]
  v_mul_f32 v50, v50, v4
  v_mul_f32 v51, v51, v4
  v_mul_f32 v52, v52, v4
  v_mul_f32 v53, v53, v4
  v_mfma_f32_32x32x16_bf16 v[24:39], v[104:107], v[240:243], 0
  v_cvt_pk_bf16_f32 v64, v40, v41
  v_cvt_pk_bf16_f32 v65, v42, v43
  s_add_u32 m0, s52, 0
  s_nop 0
  buffer_load_dwordx4 v122, s[24:27], s51 offen lds
  v_cvt_pk_bf16_f32 v66, v44, v45
  v_mfma_f32_32x32x16_bf16 v[24:39], v[108:111], v[244:247], v[24:39]
  v_cvt_pk_bf16_f32 v67, v46, v47
  v_cvt_pk_bf16_f32 v68, v48, v49
  v_cvt_pk_bf16_f32 v69, v50, v51
  v_cvt_pk_bf16_f32 v70, v52, v53
  v_mfma_f32_32x32x16_bf16 v[160:175], a[32:35], v[64:67], v[160:175]
  s_nop 6
  v_add_f32 v4, 0x358637bd, v39
  v_rcp_f32 v4, v4
  s_nop 0
  v_mul_f32 v24, v24, v4
  v_mul_f32 v25, v25, v4
  v_mfma_f32_32x32x16_bf16 v[176:191], a[40:43], v[64:67], v[176:191]
  s_add_u32 m0, s52, 0
  s_nop 0
  buffer_load_dwordx4 v123, s[24:27], s51 offen offset:1024 lds
  s_add_u32 s51, s51, 229376
  s_cmp_eq_u32 s51, s54
  s_cselect_b32 s51, s53, s51
  v_mul_f32 v26, v26, v4
  v_mul_f32 v27, v27, v4
  v_mul_f32 v28, v28, v4
  v_mfma_f32_32x32x16_bf16 v[160:175], a[36:39], v[68:71], v[160:175]
  v_mul_f32 v29, v29, v4
  v_mul_f32 v30, v30, v4
  v_mul_f32 v31, v31, v4
  v_mul_f32 v32, v32, v4
  v_mfma_f32_32x32x16_bf16 v[176:191], a[44:47], v[68:71], v[176:191]
  v_mul_f32 v33, v33, v4
  v_mul_f32 v34, v34, v4
  v_mul_f32 v35, v35, v4
  v_mul_f32 v36, v36, v4
  v_mfma_f32_32x32x16_bf16 v[40:55], v[104:107], v[248:251], 0
  v_mul_f32 v37, v37, v4
  v_cvt_pk_bf16_f32 v56, v24, v25
  v_cvt_pk_bf16_f32 v57, v26, v27
  v_cvt_pk_bf16_f32 v58, v28, v29
  v_mfma_f32_32x32x16_bf16 v[40:55], v[108:111], v[252:255], v[40:55]
  v_cvt_pk_bf16_f32 v59, v30, v31
  v_cvt_pk_bf16_f32 v60, v32, v33
  v_cvt_pk_bf16_f32 v61, v34, v35
  v_cvt_pk_bf16_f32 v62, v36, v37
  v_mfma_f32_32x32x16_bf16 v[128:143], a[48:51], v[56:59], v[128:143]
  s_nop 6
  v_add_f32 v4, 0x358637bd, v55
  v_rcp_f32 v4, v4
  s_nop 0
  v_mul_f32 v40, v40, v4
  v_mul_f32 v41, v41, v4
  v_mul_f32 v42, v42, v4
  v_mul_f32 v43, v43, v4
  v_mfma_f32_32x32x16_bf16 v[144:159], a[56:59], v[56:59], v[144:159]
  v_mul_f32 v44, v44, v4
  v_mul_f32 v45, v45, v4
  v_mul_f32 v46, v46, v4
  v_mul_f32 v47, v47, v4
  v_mul_f32 v48, v48, v4
  v_mul_f32 v49, v49, v4
  v_mfma_f32_32x32x16_bf16 v[128:143], a[52:55], v[60:63], v[128:143]
  v_mul_f32 v50, v50, v4
  v_mul_f32 v51, v51, v4
  v_mul_f32 v52, v52, v4
  v_mul_f32 v53, v53, v4
  v_cvt_pk_bf16_f32 v64, v40, v41
  v_cvt_pk_bf16_f32 v65, v42, v43
  v_mfma_f32_32x32x16_bf16 v[144:159], a[60:63], v[60:63], v[144:159]
  v_cvt_pk_bf16_f32 v66, v44, v45
  v_cvt_pk_bf16_f32 v67, v46, v47
  v_cvt_pk_bf16_f32 v68, v48, v49
  v_cvt_pk_bf16_f32 v69, v50, v51
  v_cvt_pk_bf16_f32 v70, v52, v53
  v_mfma_f32_32x32x16_bf16 v[160:175], a[48:51], v[64:67], v[160:175]
  v_mfma_f32_32x32x16_bf16 v[176:191], a[56:59], v[64:67], v[176:191]
  s_nop 4
  ds_write_b128 v73, v[144:147] offset:0
  v_mfma_f32_32x32x16_bf16 v[160:175], a[52:55], v[68:71], v[160:175]
  s_branch L_ov3
  .p2align 12
L_pg3:
  s_branch L_bk1
L_ov3:
  ds_write_b128 v73, v[148:151] offset:1024
  ds_write_b128 v73, v[152:155] offset:2048
  v_mfma_f32_32x32x16_bf16 v[176:191], a[60:63], v[68:71], v[176:191]
  ds_write_b128 v73, v[156:159] offset:3072
  s_nop 7
  ds_write_b128 v74, v[160:163] offset:0
  ds_write_b128 v74, v[164:167] offset:1024
  ds_write_b128 v74, v[168:171] offset:2048
  ds_write_b128 v74, v[172:175] offset:3072
  ds_write_b128 v75, v[176:179] offset:0
  ds_write_b128 v75, v[180:183] offset:1024
  ds_write_b128 v75, v[184:187] offset:2048
  ds_write_b128 v75, v[188:191] offset:3072
  s_waitcnt lgkmcnt(0)
  s_barrier
  ds_read_b128 v[144:147], v72 offset:0
  ds_read_b128 v[148:151], v72 offset:1024
  ds_read_b128 v[152:155], v72 offset:2048
  ds_read_b128 v[156:159], v72 offset:3072
  ds_read_b128 v[160:163], v72 offset:4096
  ds_read_b128 v[164:167], v72 offset:5120
  ds_read_b128 v[168:171], v72 offset:6144
  ds_read_b128 v[172:175], v72 offset:7168
  ds_read_b128 v[176:179], v72 offset:8192
  ds_read_b128 v[180:183], v72 offset:9216
  ds_read_b128 v[184:187], v72 offset:10240
  ds_read_b128 v[188:191], v72 offset:11264
  s_mul_i32 s56, s100, 28
  s_lshl_b32 s48, s44, 2
  s_add_u32 s56, s56, s48
  s_and_b32 s49, s40, 1
  s_lshl_b32 s48, s49, 1
  s_add_u32 s56, s56, s48
  s_lshl_b32 s56, s56, 10
  s_add_u32 s56, s56, 4194304
  s_mul_i32 s57, s100, 7
  s_add_u32 s57, s57, s44
  s_lshl_b32 s57, s57, 1
  s_add_u32 s57, s57, s49
  v_lshrrev_b32 v5, 4, v1
  v_and_b32 v4, 0xf0, v2
  v_lshl_add_u32 v4, v5, 3, v4
  s_lshl_b32 s57, s57, 8
  s_add_u32 s57, s57, 6291456
  s_lshl_b32 s58, s43, 5
  s_lshl_b32 s48, s44, 2
  s_add_u32 s58, s58, s48
  s_add_u32 s58, s58, s40
  s_lshl_b32 s58, s58, 6
  s_add_u32 s58, s58, 393216
  s_waitcnt lgkmcnt(11)
  v_pk_add_f32 v[128:129], v[128:129], v[144:145]
  v_pk_add_f32 v[130:131], v[130:131], v[146:147]
  s_waitcnt lgkmcnt(10)
  v_pk_add_f32 v[132:133], v[132:133], v[148:149]
  v_pk_add_f32 v[134:135], v[134:135], v[150:151]
  s_waitcnt lgkmcnt(9)
  v_pk_add_f32 v[136:137], v[136:137], v[152:153]
  v_pk_add_f32 v[138:139], v[138:139], v[154:155]
  s_waitcnt lgkmcnt(8)
  v_pk_add_f32 v[140:141], v[140:141], v[156:157]
  v_pk_add_f32 v[142:143], v[142:143], v[158:159]
  s_waitcnt lgkmcnt(7)
  v_pk_add_f32 v[128:129], v[128:129], v[160:161]
  v_pk_add_f32 v[130:131], v[130:131], v[162:163]
  s_waitcnt lgkmcnt(6)
  v_pk_add_f32 v[132:133], v[132:133], v[164:165]
  v_pk_add_f32 v[134:135], v[134:135], v[166:167]
  s_waitcnt lgkmcnt(5)
  v_pk_add_f32 v[136:137], v[136:137], v[168:169]
  v_pk_add_f32 v[138:139], v[138:139], v[170:171]
  s_waitcnt lgkmcnt(4)
  v_pk_add_f32 v[140:141], v[140:141], v[172:173]
  v_pk_add_f32 v[142:143], v[142:143], v[174:175]
  s_waitcnt lgkmcnt(3)
  v_pk_add_f32 v[128:129], v[128:129], v[176:177]
  v_pk_add_f32 v[130:131], v[130:131], v[178:179]
  s_waitcnt lgkmcnt(2)
  v_pk_add_f32 v[132:133], v[132:133], v[180:181]
  v_pk_add_f32 v[134:135], v[134:135], v[182:183]
  s_waitcnt lgkmcnt(1)
  v_pk_add_f32 v[136:137], v[136:137], v[184:185]
  v_pk_add_f32 v[138:139], v[138:139], v[186:187]
  s_waitcnt lgkmcnt(0)
  v_pk_add_f32 v[140:141], v[140:141], v[188:189]
  v_pk_add_f32 v[142:143], v[142:143], v[190:191]
  v_cvt_pk_bf16_f32 v16, v128, v129
  v_cvt_pk_bf16_f32 v17, v130, v131
  v_cvt_pk_bf16_f32 v18, v132, v133
  v_cvt_pk_bf16_f32 v19, v134, v135
  v_cvt_pk_bf16_f32 v20, v136, v137
  v_cvt_pk_bf16_f32 v21, v138, v139
  v_cvt_pk_bf16_f32 v22, v140, v141
  v_cvt_pk_bf16_f32 v23, v142, v143
  buffer_store_dwordx4 v[16:19], v2, s[12:15], s56 offen sc1
  buffer_store_dwordx4 v[20:23], v2, s[12:15], s56 offen offset:1024 sc1
  s_mov_b32 s48, 1065369472
  v_mov_b32 v8, 0
  v_mov_b32 v9, 0
  v_dot2c_f32_bf16 v8, s48, v16
  v_dot2c_f32_bf16 v9, v16, v16
  v_dot2c_f32_bf16 v8, s48, v17
  v_dot2c_f32_bf16 v9, v17, v17
  v_dot2c_f32_bf16 v8, s48, v18
  v_dot2c_f32_bf16 v9, v18, v18
  v_dot2c_f32_bf16 v8, s48, v19
  v_dot2c_f32_bf16 v9, v19, v19
  v_dot2c_f32_bf16 v8, s48, v20
  v_dot2c_f32_bf16 v9, v20, v20
  v_dot2c_f32_bf16 v8, s48, v21
  v_dot2c_f32_bf16 v9, v21, v21
  v_dot2c_f32_bf16 v8, s48, v22
  v_dot2c_f32_bf16 v9, v22, v22
  v_dot2c_f32_bf16 v8, s48, v23
  v_dot2c_f32_bf16 v9, v23, v23
  s_nop 1
  v_mov_b32 v10, v8
  v_mov_b32 v11, v9
  s_nop 0
  v_permlane32_swap_b32 v8, v10
  v_permlane32_swap_b32 v9, v11
  v_add_f32 v8, v8, v10
  v_add_f32 v9, v9, v11
  s_mov_b32 exec_hi, 0
  buffer_store_dwordx2 v[8:9], v4, s[12:15], s57 offen sc1
  s_mov_b32 exec_hi, -1
  s_waitcnt vmcnt(0)
  s_mov_b64 exec, 1
  v_mov_b32 v3, s1
  buffer_store_dword v3, off, s[12:15], s58  sc1
  s_mov_b64 exec, -1
  s_add_u32 m0, s52, 8192
  s_nop 0
  buffer_load_dwordx4 v122, s[24:27], s51 offen lds
  s_add_u32 m0, s52, 8192
  s_nop 0
  buffer_load_dwordx4 v123, s[24:27], s51 offen offset:1024 lds
  s_add_u32 s51, s51, 229376
  s_cmp_eq_u32 s51, s54
  s_cselect_b32 s51, s53, s51
  s_add_u32 m0, s52, 16384
  s_nop 0
  buffer_load_dwordx4 v122, s[24:27], s51 offen lds
  s_add_u32 m0, s52, 16384
  s_nop 0
  buffer_load_dwordx4 v123, s[24:27], s51 offen offset:1024 lds
  s_add_u32 s51, s51, 229376
  s_cmp_eq_u32 s51, s54
  s_cselect_b32 s51, s53, s51
  s_add_u32 m0, s52, 24576
  s_nop 0
  buffer_load_dwordx4 v122, s[24:27], s51 offen lds
  s_add_u32 m0, s52, 24576
  s_nop 0
  buffer_load_dwordx4 v123, s[24:27], s51 offen offset:1024 lds
  s_add_u32 s51, s51, 229376
  s_cmp_eq_u32 s51, s54
  s_cselect_b32 s51, s53, s51
  s_add_u32 m0, s52, 32768
  s_nop 0
  buffer_load_dwordx4 v122, s[24:27], s51 offen lds
  s_add_u32 m0, s52, 32768
  s_nop 0
  buffer_load_dwordx4 v123, s[24:27], s51 offen offset:1024 lds
  s_add_u32 s51, s51, 229376
  s_cmp_eq_u32 s51, s54
  s_cselect_b32 s51, s53, s51
  s_add_u32 m0, s52, 40960
  s_nop 0
  buffer_load_dwordx4 v122, s[24:27], s51 offen lds
  s_add_u32 m0, s52, 40960
  s_nop 0
  buffer_load_dwordx4 v123, s[24:27], s51 offen offset:1024 lds
  s_add_u32 s51, s51, 229376
  s_cmp_eq_u32 s51, s54
  s_cselect_b32 s51, s53, s51
  s_add_u32 m0, s52, 49152
  s_nop 0
  buffer_load_dwordx4 v122, s[24:27], s51 offen lds
  s_add_u32 m0, s52, 49152
  s_nop 0
  buffer_load_dwordx4 v123, s[24:27], s51 offen offset:1024 lds
  s_add_u32 s51, s51, 229376
  s_cmp_eq_u32 s51, s54
  s_cselect_b32 s51, s53, s51
  v_bfe_u32 v4, v1, 4, 1
  v_mul_u32_u24 v3, 57344, v4
  v_lshrrev_b32 v5, 5, v1
  v_lshl_add_u32 v3, v5, 10, v3
  v_bfe_u32 v5, v1, 2, 2
  v_lshl_add_u32 v3, v5, 7, v3
  v_and_b32 v5, 1, v1
  v_lshl_add_u32 v3, v5, 4, v3
  v_bfe_u32 v5, v1, 1, 1
  v_lshl_add_u32 v3, v5, 3, v3
  v_bfe_u32 v5, v1, 3, 2
  v_lshl_add_u32 v3, v5, 5, v3
  v_xor_b32 v24, 0, v3
  v_xor_b32 v25, 32, v3
  v_xor_b32 v26, 64, v3
  v_xor_b32 v27, 96, v3
  s_lshl_b32 s53, s45, 2
  s_add_u32 s53, s53, s40
  s_mul_i32 s55, s53, 57344
  s_add_u32 s55, s55, 4194304
  s_lshl_b32 s54, s0, 12
  s_add_u32 s54, s54, s55
  s_add_u32 s52, s55, 28672
  v_add_u32 v15, 28672, v2
  s_mul_i32 s56, s53, 7168
  s_add_u32 s56, s56, 6291456
  s_mul_i32 s58, s53, 224
  s_lshl_b32 s48, s46, 2
  s_add_u32 s58, s58, s48
  s_lshl_b32 s58, s58, 10
  s_add_u32 s58, s58, 8388608
  s_add_u32 s59, s58, 114688
  s_lshl_b32 s50, s53, 11
  s_add_u32 s50, s50, 393216
  s_lshl_b32 s51, s53, 5
  s_add_u32 s51, s51, s46
  s_lshl_b32 s51, s51, 6
  s_add_u32 s51, s51, 524288
  v_lshrrev_b32 v6, 5, v1
  v_mul_u32_u24 v6, 3072, v6
  v_add_u32 v7, v2, v6
  v_min_u32 v4, 27, v1
  v_lshlrev_b32 v4, 6, v4
  v_mov_b32 v56, 0
  v_mov_b32 v57, 0
  v_mov_b32 v58, 0
  v_mov_b32 v59, 0
  v_mov_b32 v60, 0
  v_mov_b32 v61, 0
  v_mov_b32 v62, 0
  v_mov_b32 v63, 0
  v_and_b32 v12, 0x1f0, v2
  s_lshl_b32 s48, s46, 9
  s_add_u32 s48, s48, 655360
  v_add_u32 v12, s48, v12
  s_waitcnt vmcnt(0)
  s_barrier
  ds_read_b64_tr_b16 v[80:81], v24 offset:0
  ds_read_b64_tr_b16 v[82:83], v24 offset:512
  ds_read_b64_tr_b16 v[84:85], v25 offset:0
  ds_read_b64_tr_b16 v[86:87], v25 offset:512
  ds_read_b64_tr_b16 v[88:89], v26 offset:0
  ds_read_b64_tr_b16 v[90:91], v26 offset:512
  ds_read_b64_tr_b16 v[92:93], v27 offset:0
  ds_read_b64_tr_b16 v[94:95], v27 offset:512
  ds_read_b64_tr_b16 v[96:97], v24 offset:2048
  ds_read_b64_tr_b16 v[98:99], v24 offset:2560
  ds_read_b64_tr_b16 v[100:101], v25 offset:2048
  ds_read_b64_tr_b16 v[102:103], v25 offset:2560
  s_mov_b32 s48, 262144
L_poll_p3:
  buffer_load_dword v5, v4, s[12:15], s50 offen sc1
  s_sub_u32 s48, s48, 1
  s_waitcnt vmcnt(0)
  v_cmp_eq_u32 vcc, s1, v5
  s_cbranch_scc1 L_pollx_p3
  s_andn2_b32 s49, 0x0fffffff, vcc_lo
  s_cbranch_scc1 L_poll_p3
L_pollx_p3:
  buffer_load_dwordx4 a[0:3], v2, s[12:15], s54 offen offset:0 sc1
  buffer_load_dwordx4 a[4:7], v15, s[12:15], s54 offen offset:0 sc1
  buffer_load_dwordx4 a[8:11], v2, s[12:15], s54 offen offset:1024 sc1
  buffer_load_dwordx4 a[12:15], v15, s[12:15], s54 offen offset:1024 sc1
  buffer_load_dwordx4 a[16:19], v2, s[12:15], s54 offen offset:2048 sc1
  buffer_load_dwordx4 a[20:23], v15, s[12:15], s54 offen offset:2048 sc1
  buffer_load_dwordx4 a[24:27], v2, s[12:15], s54 offen offset:3072 sc1
  buffer_load_dwordx4 a[28:31], v15, s[12:15], s54 offen offset:3072 sc1
  s_add_u32 s54, s54, 4096
  s_cmp_eq_u32 s54, s52
  s_cselect_b32 s54, s55, s54
  buffer_load_dwordx4 a[32:35], v2, s[12:15], s54 offen offset:0 sc1
  buffer_load_dwordx4 a[36:39], v15, s[12:15], s54 offen offset:0 sc1
  buffer_load_dwordx4 a[40:43], v2, s[12:15], s54 offen offset:1024 sc1
  buffer_load_dwordx4 a[44:47], v15, s[12:15], s54 offen offset:1024 sc1
  s_waitcnt vmcnt(11) lgkmcnt(10)
  v_mfma_f32_32x32x16_bf16 v[128:143], v[80:83], a[0:3], 0
  ds_read_b64_tr_b16 v[104:105], v26 offset:2048
  s_waitcnt vmcnt(10)
  v_mfma_f32_32x32x16_bf16 v[192:207], v[80:83], a[4:7], 0
  ds_read_b64_tr_b16 v[106:107], v26 offset:2560
  buffer_load_dwordx4 a[48:51], v2, s[12:15], s54 offen offset:2048 sc1
  s_waitcnt lgkmcnt(10)
  v_mfma_f32_32x32x16_bf16 v[144:159], v[84:87], a[0:3], 0
  ds_read_b64_tr_b16 v[108:109], v27 offset:2048
  v_mfma_f32_32x32x16_bf16 v[208:223], v[84:87], a[4:7], 0
  ds_read_b64_tr_b16 v[110:111], v27 offset:2560
  buffer_load_dwordx4 a[52:55], v15, s[12:15], s54 offen offset:2048 sc1
  s_waitcnt lgkmcnt(10)
  v_mfma_f32_32x32x16_bf16 v[160:175], v[88:91], a[0:3], 0
  ds_read_b64_tr_b16 v[80:81], v24 offset:4096
  v_mfma_f32_32x32x16_bf16 v[224:239], v[88:91], a[4:7], 0
  ds_read_b64_tr_b16 v[82:83], v24 offset:4608
  buffer_load_dwordx4 a[56:59], v2, s[12:15], s54 offen offset:3072 sc1
  s_waitcnt lgkmcnt(10)
  v_mfma_f32_32x32x16_bf16 v[176:191], v[92:95], a[0:3], 0
  ds_read_b64_tr_b16 v[84:85], v25 offset:4096
  buffer_load_dwordx4 a[60:63], v15, s[12:15], s54 offen offset:3072 sc1
  s_add_u32 s54, s54, 4096
  s_cmp_eq_u32 s54, s52
  s_cselect_b32 s54, s55, s54
  v_mfma_f32_32x32x16_bf16 v[240:255], v[92:95], a[4:7], 0
  ds_read_b64_tr_b16 v[86:87], v25 offset:4608
  s_waitcnt vmcnt(13) lgkmcnt(10)
  v_mfma_f32_32x32x16_bf16 v[128:143], v[96:99], a[8:11], v[128:143]
  ds_read_b64_tr_b16 v[88:89], v26 offset:4096
  buffer_load_dwordx4 a[64:67], v2, s[12:15], s54 offen offset:0 sc1
  s_waitcnt vmcnt(13)
  v_mfma_f32_32x32x16_bf16 v[192:207], v[96:99], a[12:15], v[192:207]
  ds_read_b64_tr_b16 v[90:91], v26 offset:4608
  s_waitcnt lgkmcnt(10)
  v_mfma_f32_32x32x16_bf16 v[144:159], v[100:103], a[8:11], v[144:159]
  ds_read_b64_tr_b16 v[92:93], v27 offset:4096
  buffer_load_dwordx4 a[68:71], v15, s[12:15], s54 offen offset:0 sc1
  v_mfma_f32_32x32x16_bf16 v[208:223], v[100:103], a[12:15], v[208:223]
  ds_read_b64_tr_b16 v[94:95], v27 offset:4608
  buffer_load_dwordx4 a[72:75], v2, s[12:15], s54 offen offset:1024 sc1
  s_waitcnt lgkmcnt(10)
  v_mfma_f32_32x32x16_bf16 v[160:175], v[104:107], a[8:11], v[160:175]
  ds_read_b64_tr_b16 v[96:97], v24 offset:6144
  v_mfma_f32_32x32x16_bf16 v[224:239], v[104:107], a[12:15], v[224:239]
  ds_read_b64_tr_b16 v[98:99], v24 offset:6656
  buffer_load_dwordx4 a[76:79], v15, s[12:15], s54 offen offset:1024 sc1
  s_waitcnt lgkmcnt(10)
  v_mfma_f32_32x32x16_bf16 v[176:191], v[108:111], a[8:11], v[176:191]
  ds_read_b64_tr_b16 v[100:101], v25 offset:6144
  v_mfma_f32_32x32x16_bf16 v[240:255], v[108:111], a[12:15], v[240:255]
  ds_read_b64_tr_b16 v[102:103], v25 offset:6656
  buffer_load_dwordx4 a[80:83], v2, s[12:15], s54 offen offset:2048 sc1
  s_waitcnt vmcnt(16) lgkmcnt(10)
  v_mfma_f32_32x32x16_bf16 v[128:143], v[80:83], a[16:19], v[128:143]
  ds_read_b64_tr_b16 v[104:105], v26 offset:6144
  buffer_load_dwordx4 a[84:87], v15, s[12:15], s54 offen offset:2048 sc1
  s_waitcnt vmcnt(16)
  v_mfma_f32_32x32x16_bf16 v[192:207], v[80:83], a[20:23], v[192:207]
  ds_read_b64_tr_b16 v[106:107], v26 offset:6656
  s_waitcnt lgkmcnt(10)
  v_mfma_f32_32x32x16_bf16 v[144:159], v[84:87], a[16:19], v[144:159]
  ds_read_b64_tr_b16 v[108:109], v27 offset:6144
  buffer_load_dwordx4 a[88:91], v2, s[12:15], s54 offen offset:3072 sc1
  v_mfma_f32_32x32x16_bf16 v[208:223], v[84:87], a[20:23], v[208:223]
  ds_read_b64_tr_b16 v[110:111], v27 offset:6656
  s_waitcnt lgkmcnt(10)
  v_mfma_f32_32x32x16_bf16 v[160:175], v[88:91], a[16:19], v[160:175]
  ds_read_b64_tr_b16 v[80:81], v24 offset:8192
  buffer_load_dwordx4 a[92:95], v15, s[12:15], s54 offen offset:3072 sc1
  s_add_u32 s54, s54, 4096
  s_cmp_eq_u32 s54, s52
  s_cselect_b32 s54, s55, s54
  v_mfma_f32_32x32x16_bf16 v[224:239], v[88:91], a[20:23], v[224:239]
  ds_read_b64_tr_b16 v[82:83], v24 offset:8704
  buffer_load_dwordx4 a[0:3], v2, s[12:15], s54 offen offset:0 sc1
  s_waitcnt lgkmcnt(10)
  v_mfma_f32_32x32x16_bf16 v[176:191], v[92:95], a[16:19], v[176:191]
  ds_read_b64_tr_b16 v[84:85], v25 offset:8192
  v_mfma_f32_32x32x16_bf16 v[240:255], v[92:95], a[20:23], v[240:255]
  ds_read_b64_tr_b16 v[86:87], v25 offset:8704
  buffer_load_dwordx4 a[4:7], v15, s[12:15], s54 offen offset:0 sc1
  s_waitcnt vmcnt(19) lgkmcnt(10)
  v_mfma_f32_32x32x16_bf16 v[128:143], v[96:99], a[24:27], v[128:143]
  ds_read_b64_tr_b16 v[88:89], v26 offset:8192
  s_waitcnt vmcnt(18)
  v_mfma_f32_32x32x16_bf16 v[192:207], v[96:99], a[28:31], v[192:207]
  ds_read_b64_tr_b16 v[90:91], v26 offset:8704
  buffer_load_dwordx4 a[8:11], v2, s[12:15], s54 offen offset:1024 sc1
  s_waitcnt lgkmcnt(10)
  v_mfma_f32_32x32x16_bf16 v[144:159], v[100:103], a[24:27], v[144:159]
  ds_read_b64_tr_b16 v[92:93], v27 offset:8192
  buffer_load_dwordx4 a[12:15], v15, s[12:15], s54 offen offset:1024 sc1
  v_mfma_f32_32x32x16_bf16 v[208:223], v[100:103], a[28:31], v[208:223]
  ds_read_b64_tr_b16 v[94:95], v27 offset:8704
  s_waitcnt lgkmcnt(10)
  v_mfma_f32_32x32x16_bf16 v[160:175], v[104:107], a[24:27], v[160:175]
  ds_read_b64_tr_b16 v[96:97], v24 offset:10240
  buffer_load_dwordx4 a[16:19], v2, s[12:15], s54 offen offset:2048 sc1
  v_mfma_f32_32x32x16_bf16 v[224:239], v[104:107], a[28:31], v[224:239]
  ds_read_b64_tr_b16 v[98:99], v24 offset:10752
  s_waitcnt lgkmcnt(10)
  v_mfma_f32_32x32x16_bf16 v[176:191], v[108:111], a[24:27], v[176:191]
  ds_read_b64_tr_b16 v[100:101], v25 offset:10240
  buffer_load_dwordx4 a[20:23], v15, s[12:15], s54 offen offset:2048 sc1
  v_mfma_f32_32x32x16_bf16 v[240:255], v[108:111], a[28:31], v[240:255]
  ds_read_b64_tr_b16 v[102:103], v25 offset:10752
  buffer_load_dwordx4 a[24:27], v2, s[12:15], s54 offen offset:3072 sc1
  s_waitcnt vmcnt(22) lgkmcnt(10)
  v_mfma_f32_32x32x16_bf16 v[128:143], v[80:83], a[32:35], v[128:143]
  ds_read_b64_tr_b16 v[104:105], v26 offset:10240
  s_waitcnt vmcnt(21)
  v_mfma_f32_32x32x16_bf16 v[192:207], v[80:83], a[36:39], v[192:207]
  ds_read_b64_tr_b16 v[106:107], v26 offset:10752
  buffer_load_dwordx4 a[28:31], v15, s[12:15], s54 offen offset:3072 sc1
  s_add_u32 s54, s54, 4096
  s_cmp_eq_u32 s54, s52
  s_cselect_b32 s54, s55, s54
  s_waitcnt lgkmcnt(10)
  v_mfma_f32_32x32x16_bf16 v[144:159], v[84:87], a[32:35], v[144:159]
  ds_read_b64_tr_b16 v[108:109], v27 offset:10240
  v_mfma_f32_32x32x16_bf16 v[208:223], v[84:87], a[36:39], v[208:223]
  ds_read_b64_tr_b16 v[110:111], v27 offset:10752
  s_waitcnt lgkmcnt(10)
  v_mfma_f32_32x32x16_bf16 v[160:175], v[88:91], a[32:35], v[160:175]
  ds_read_b64_tr_b16 v[80:81], v24 offset:12288
  v_mfma_f32_32x32x16_bf16 v[224:239], v[88:91], a[36:39], v[224:239]
  ds_read_b64_tr_b16 v[82:83], v24 offset:12800
  s_waitcnt lgkmcnt(10)
  v_mfma_f32_32x32x16_bf16 v[176:191], v[92:95], a[32:35], v[176:191]
  ds_read_b64_tr_b16 v[84:85], v25 offset:12288
  buffer_load_dwordx4 a[32:35], v2, s[12:15], s54 offen offset:0 sc1
  v_mfma_f32_32x32x16_bf16 v[240:255], v[92:95], a[36:39], v[240:255]
  ds_read_b64_tr_b16 v[86:87], v25 offset:12800
  buffer_load_dwordx4 a[36:39], v15, s[12:15], s54 offen offset:0 sc1
  s_waitcnt vmcnt(23) lgkmcnt(10)
  v_mfma_f32_32x32x16_bf16 v[128:143], v[96:99], a[40:43], v[128:143]
  ds_read_b64_tr_b16 v[88:89], v26 offset:12288
  s_waitcnt vmcnt(22)
  v_mfma_f32_32x32x16_bf16 v[192:207], v[96:99], a[44:47], v[192:207]
  ds_read_b64_tr_b16 v[90:91], v26 offset:12800
  buffer_load_dwordx4 v[28:31], v7, s[12:15], s56 offen offset:0 sc1
  s_waitcnt lgkmcnt(10)
  v_mfma_f32_32x32x16_bf16 v[144:159], v[100:103], a[40:43], v[144:159]
  ds_read_b64_tr_b16 v[92:93], v27 offset:12288
  buffer_load_dwordx4 v[32:35], v7, s[12:15], s56 offen offset:512 sc1
  v_mfma_f32_32x32x16_bf16 v[208:223], v[100:103], a[44:47], v[208:223]
  ds_read_b64_tr_b16 v[94:95], v27 offset:12800
  s_waitcnt lgkmcnt(10)
  v_mfma_f32_32x32x16_bf16 v[160:175], v[104:107], a[40:43], v[160:175]
  ds_read_b64_tr_b16 v[96:97], v24 offset:14336
  buffer_load_dwordx4 v[36:39], v7, s[12:15], s56 offen offset:1024 sc1
  v_mfma_f32_32x32x16_bf16 v[224:239], v[104:107], a[44:47], v[224:239]
  ds_read_b64_tr_b16 v[98:99], v24 offset:14848
  buffer_load_dwordx4 v[40:43], v7, s[12:15], s56 offen offset:1536 sc1
  s_waitcnt lgkmcnt(10)
  v_mfma_f32_32x32x16_bf16 v[176:191], v[108:111], a[40:43], v[176:191]
  ds_read_b64_tr_b16 v[100:101], v25 offset:14336
  v_mfma_f32_32x32x16_bf16 v[240:255], v[108:111], a[44:47], v[240:255]
  ds_read_b64_tr_b16 v[102:103], v25 offset:14848
  buffer_load_dwordx4 v[44:47], v7, s[12:15], s56 offen offset:2048 sc1
  s_waitcnt vmcnt(26) lgkmcnt(10)
  v_mfma_f32_32x32x16_bf16 v[128:143], v[80:83], a[48:51], v[128:143]
  ds_read_b64_tr_b16 v[104:105], v26 offset:14336
  buffer_load_dwordx4 v[48:51], v7, s[12:15], s56 offen offset:2560 sc1
  s_waitcnt vmcnt(26)
  v_mfma_f32_32x32x16_bf16 v[192:207], v[80:83], a[52:55], v[192:207]
  ds_read_b64_tr_b16 v[106:107], v26 offset:14848
  s_waitcnt lgkmcnt(10)
  v_mfma_f32_32x32x16_bf16 v[144:159], v[84:87], a[48:51], v[144:159]
  ds_read_b64_tr_b16 v[108:109], v27 offset:14336
  buffer_load_dwordx4 v[52:55], v7, s[12:15], s56 offen offset:3072 sc1
  v_mfma_f32_32x32x16_bf16 v[208:223], v[84:87], a[52:55], v[208:223]
  ds_read_b64_tr_b16 v[110:111], v27 offset:14848
  buffer_load_dwordx4 v[64:67], v12, s[12:15], 0 offen sc1
  s_waitcnt lgkmcnt(10)
  v_mfma_f32_32x32x16_bf16 v[160:175], v[88:91], a[48:51], v[160:175]
  ds_read_b64_tr_b16 v[80:81], v24 offset:16384
  v_mfma_f32_32x32x16_bf16 v[224:239], v[88:91], a[52:55], v[224:239]
  ds_read_b64_tr_b16 v[82:83], v24 offset:16896
  s_add_u32 m0, s19, 0
  s_nop 0
  buffer_load_dwordx4 v76, s[32:35], s16 offen lds
  s_waitcnt lgkmcnt(10)
  v_mfma_f32_32x32x16_bf16 v[176:191], v[92:95], a[48:51], v[176:191]
  ds_read_b64_tr_b16 v[84:85], v25 offset:16384
  buffer_load_dwordx4 v77, s[32:35], s16 offen offset:1024 lds
  s_add_u32 s16, s16, 14336
  v_mfma_f32_32x32x16_bf16 v[240:255], v[92:95], a[52:55], v[240:255]
  ds_read_b64_tr_b16 v[86:87], v25 offset:16896
  s_waitcnt vmcnt(29) lgkmcnt(10)
  v_mfma_f32_32x32x16_bf16 v[128:143], v[96:99], a[56:59], v[128:143]
  ds_read_b64_tr_b16 v[88:89], v26 offset:16384
  s_add_u32 m0, s19, 2048
  s_nop 0
  buffer_load_dwordx4 v76, s[32:35], s16 offen lds
  s_waitcnt vmcnt(29)
  v_mfma_f32_32x32x16_bf16 v[192:207], v[96:99], a[60:63], v[192:207]
  ds_read_b64_tr_b16 v[90:91], v26 offset:16896
  buffer_load_dwordx4 v77, s[32:35], s16 offen offset:1024 lds
  s_add_u32 s16, s16, 14336
  s_waitcnt lgkmcnt(10)
  v_mfma_f32_32x32x16_bf16 v[144:159], v[100:103], a[56:59], v[144:159]
  ds_read_b64_tr_b16 v[92:93], v27 offset:16384
  v_mfma_f32_32x32x16_bf16 v[208:223], v[100:103], a[60:63], v[208:223]
  ds_read_b64_tr_b16 v[94:95], v27 offset:16896
  s_add_u32 m0, s19, 4096
  s_nop 0
  buffer_load_dwordx4 v76, s[32:35], s16 offen lds
  s_waitcnt lgkmcnt(10)
  v_mfma_f32_32x32x16_bf16 v[160:175], v[104:107], a[56:59], v[160:175]
  ds_read_b64_tr_b16 v[96:97], v24 offset:18432
  buffer_load_dwordx4 v77, s[32:35], s16 offen offset:1024 lds
  s_add_u32 s16, s16, 14336
  v_mfma_f32_32x32x16_bf16 v[224:239], v[104:107], a[60:63], v[224:239]
  ds_read_b64_tr_b16 v[98:99], v24 offset:18944
  s_waitcnt lgkmcnt(10)
  v_mfma_f32_32x32x16_bf16 v[176:191], v[108:111], a[56:59], v[176:191]
  ds_read_b64_tr_b16 v[100:101], v25 offset:18432
  s_add_u32 m0, s19, 6144
  s_nop 0
  buffer_load_dwordx4 v76, s[32:35], s16 offen lds
  v_mfma_f32_32x32x16_bf16 v[240:255], v[108:111], a[60:63], v[240:255]
  ds_read_b64_tr_b16 v[102:103], v25 offset:18944
  buffer_load_dwordx4 v77, s[32:35], s16 offen offset:1024 lds
  s_add_u32 s16, s16, 14336
  s_cmp_eq_u32 s16, s18
  s_cselect_b32 s16, s17, s16
  s_waitcnt vmcnt(33) lgkmcnt(10)
  v_mfma_f32_32x32x16_bf16 v[128:143], v[80:83], a[64:67], v[128:143]
  ds_read_b64_tr_b16 v[104:105], v26 offset:18432
  s_waitcnt vmcnt(32)
  v_mfma_f32_32x32x16_bf16 v[192:207], v[80:83], a[68:71], v[192:207]
  ds_read_b64_tr_b16 v[106:107], v26 offset:18944
  s_add_u32 m0, s19, 8192
  s_nop 0
  buffer_load_dwordx4 v76, s[32:35], s16 offen lds
  s_waitcnt lgkmcnt(10)
  v_mfma_f32_32x32x16_bf16 v[144:159], v[84:87], a[64:67], v[144:159]
  ds_read_b64_tr_b16 v[108:109], v27 offset:18432
  buffer_load_dwordx4 v77, s[32:35], s16 offen offset:1024 lds
  s_add_u32 s16, s16, 14336
  v_mfma_f32_32x32x16_bf16 v[208:223], v[84:87], a[68:71], v[208:223]
  ds_read_b64_tr_b16 v[110:111], v27 offset:18944
  s_waitcnt lgkmcnt(10)
  v_mfma_f32_32x32x16_bf16 v[160:175], v[88:91], a[64:67], v[160:175]
  ds_read_b64_tr_b16 v[80:81], v24 offset:20480
  s_add_u32 m0, s19, 10240
  s_nop 0
  buffer_load_dwordx4 v76, s[32:35], s16 offen lds
  v_mfma_f32_32x32x16_bf16 v[224:239], v[88:91], a[68:71], v[224:239]
  ds_read_b64_tr_b16 v[82:83], v24 offset:20992
  buffer_load_dwordx4 v77, s[32:35], s16 offen offset:1024 lds
  s_add_u32 s16, s16, 14336
  s_waitcnt lgkmcnt(10)
  v_mfma_f32_32x32x16_bf16 v[176:191], v[92:95], a[64:67], v[176:191]
  ds_read_b64_tr_b16 v[84:85], v25 offset:20480
  v_mfma_f32_32x32x16_bf16 v[240:255], v[92:95], a[68:71], v[240:255]
  ds_read_b64_tr_b16 v[86:87], v25 offset:20992
  s_waitcnt vmcnt(35) lgkmcnt(10)
  v_mfma_f32_32x32x16_bf16 v[128:143], v[96:99], a[72:75], v[128:143]
  ds_read_b64_tr_b16 v[88:89], v26 offset:20480
  s_waitcnt vmcnt(34)
  v_mfma_f32_32x32x16_bf16 v[192:207], v[96:99], a[76:79], v[192:207]
  ds_read_b64_tr_b16 v[90:91], v26 offset:20992
  s_waitcnt lgkmcnt(10)
  v_mfma_f32_32x32x16_bf16 v[144:159], v[100:103], a[72:75], v[144:159]
  ds_read_b64_tr_b16 v[92:93], v27 offset:20480
  v_mfma_f32_32x32x16_bf16 v[208:223], v[100:103], a[76:79], v[208:223]
  ds_read_b64_tr_b16 v[94:95], v27 offset:20992
  s_waitcnt lgkmcnt(10)
  v_mfma_f32_32x32x16_bf16 v[160:175], v[104:107], a[72:75], v[160:175]
  ds_read_b64_tr_b16 v[96:97], v24 offset:22528
  v_mfma_f32_32x32x16_bf16 v[224:239], v[104:107], a[76:79], v[224:239]
  ds_read_b64_tr_b16 v[98:99], v24 offset:23040
  s_waitcnt lgkmcnt(10)
  v_mfma_f32_32x32x16_bf16 v[176:191], v[108:111], a[72:75], v[176:191]
  ds_read_b64_tr_b16 v[100:101], v25 offset:22528
  v_mfma_f32_32x32x16_bf16 v[240:255], v[108:111], a[76:79], v[240:255]
  ds_read_b64_tr_b16 v[102:103], v25 offset:23040
  s_waitcnt vmcnt(33) lgkmcnt(10)
  v_mfma_f32_32x32x16_bf16 v[128:143], v[80:83], a[80:83], v[128:143]
  ds_read_b64_tr_b16 v[104:105], v26 offset:22528
  s_mov_b32 s48, 262144
  s_mov_b32 s49, 0x0c0c0400
L_cs:
  s_waitcnt vmcnt(12)
  v_perm_b32 v68, v65, v64, s49
  v_perm_b32 v69, v67, v66, s49
  v_lshl_or_b32 v68, v69, 16, v68
  v_cmp_ne_u32 vcc, s1, v68
  s_cbranch_vccz L_csx
  buffer_load_dwordx4 v[64:67], v12, s[12:15], 0 offen sc1
  s_sub_u32 s48, s48, 1
  s_waitcnt vmcnt(0)
  s_cbranch_scc0 L_cs
L_csx:
  v_cvt_pk_bf16_f32 v68, v64, v64
  v_mfma_f32_32x32x16_bf16 v[192:207], v[80:83], a[84:87], v[192:207]
  ds_read_b64_tr_b16 v[106:107], v26 offset:23040
  v_cvt_pk_bf16_f32 v69, v65, v65
  v_cvt_pk_bf16_f32 v70, v66, v66
  s_waitcnt lgkmcnt(10)
  v_mfma_f32_32x32x16_bf16 v[144:159], v[84:87], a[80:83], v[144:159]
  ds_read_b64_tr_b16 v[108:109], v27 offset:22528
  v_cvt_pk_bf16_f32 v71, v67, v67
  v_lshlrev_b32 v68, 16, v68
  v_mfma_f32_32x32x16_bf16 v[208:223], v[84:87], a[84:87], v[208:223]
  ds_read_b64_tr_b16 v[110:111], v27 offset:23040
  v_lshlrev_b32 v69, 16, v69
  v_lshlrev_b32 v70, 16, v70
  s_waitcnt lgkmcnt(10)
  v_mfma_f32_32x32x16_bf16 v[160:175], v[88:91], a[80:83], v[160:175]
  ds_read_b64_tr_b16 v[80:81], v24 offset:24576
  v_lshlrev_b32 v71, 16, v71
  v_sub_f32 v68, v64, v68
  v_mfma_f32_32x32x16_bf16 v[224:239], v[88:91], a[84:87], v[224:239]
  ds_read_b64_tr_b16 v[82:83], v24 offset:25088
  v_sub_f32 v69, v65, v69
  v_sub_f32 v70, v66, v70
  s_waitcnt lgkmcnt(10)
  v_mfma_f32_32x32x16_bf16 v[176:191], v[92:95], a[80:83], v[176:191]
  ds_read_b64_tr_b16 v[84:85], v25 offset:24576
  v_sub_f32 v71, v67, v71
  v_cvt_pk_bf16_f32 v112, v64, v68
  v_mfma_f32_32x32x16_bf16 v[240:255], v[92:95], a[84:87], v[240:255]
  ds_read_b64_tr_b16 v[86:87], v25 offset:25088
  v_cvt_pk_bf16_f32 v113, v64, v68
  v_cvt_pk_bf16_f32 v114, v65, v69
  s_waitcnt lgkmcnt(10)
  v_mfma_f32_32x32x16_bf16 v[128:143], v[96:99], a[88:91], v[128:143]
  ds_read_b64_tr_b16 v[88:89], v26 offset:24576
  v_cvt_pk_bf16_f32 v115, v65, v69
  v_cvt_pk_bf16_f32 v116, v66, v70
  v_mfma_f32_32x32x16_bf16 v[192:207], v[96:99], a[92:95], v[192:207]
  ds_read_b64_tr_b16 v[90:91], v26 offset:25088
  v_cvt_pk_bf16_f32 v117, v66, v70
  v_cvt_pk_bf16_f32 v118, v67, v71
  s_waitcnt lgkmcnt(10)
  v_mfma_f32_32x32x16_bf16 v[144:159], v[100:103], a[88:91], v[144:159]
  s_branch L_ov4
  .p2align 12
L_pg4:
  s_branch L_bk1
L_ov4:
  ds_read_b64_tr_b16 v[92:93], v27 offset:24576
  v_cvt_pk_bf16_f32 v119, v67, v71
  v_mov_b32 v120, 0
  v_mfma_f32_32x32x16_bf16 v[208:223], v[100:103], a[92:95], v[208:223]
  ds_read_b64_tr_b16 v[94:95], v27 offset:25088
  v_mov_b32 v121, 0
  s_waitcnt lgkmcnt(10)
  v_mfma_f32_32x32x16_bf16 v[160:175], v[104:107], a[88:91], v[160:175]
  ds_read_b64_tr_b16 v[96:97], v24 offset:26624
  v_add_f32 v28, v28, v32
  v_add_f32 v30, v30, v34
  v_mfma_f32_32x32x16_bf16 v[224:239], v[104:107], a[92:95], v[224:239]
  ds_read_b64_tr_b16 v[98:99], v24 offset:27136
  v_add_f32 v29, v29, v33
  v_add_f32 v31, v31, v35
  s_waitcnt lgkmcnt(10)
  v_mfma_f32_32x32x16_bf16 v[176:191], v[108:111], a[88:91], v[176:191]
  ds_read_b64_tr_b16 v[100:101], v25 offset:26624
  v_add_f32 v28, v28, v36
  v_add_f32 v30, v30, v38
  v_mfma_f32_32x32x16_bf16 v[240:255], v[108:111], a[92:95], v[240:255]
  ds_read_b64_tr_b16 v[102:103], v25 offset:27136
  v_add_f32 v29, v29, v37
  v_add_f32 v31, v31, v39
  s_waitcnt lgkmcnt(10)
  v_mfma_f32_32x32x16_bf16 v[128:143], v[80:83], a[0:3], v[128:143]
  ds_read_b64_tr_b16 v[104:105], v26 offset:26624
  v_add_f32 v28, v28, v40
  v_add_f32 v30, v30, v42
  v_mfma_f32_32x32x16_bf16 v[192:207], v[80:83], a[4:7], v[192:207]
  ds_read_b64_tr_b16 v[106:107], v26 offset:27136
  v_add_f32 v29, v29, v41
  v_add_f32 v31, v31, v43
  s_waitcnt lgkmcnt(10)
  v_mfma_f32_32x32x16_bf16 v[144:159], v[84:87], a[0:3], v[144:159]
  ds_read_b64_tr_b16 v[108:109], v27 offset:26624
  v_add_f32 v28, v28, v44
  v_add_f32 v30, v30, v46
  v_mfma_f32_32x32x16_bf16 v[208:223], v[84:87], a[4:7], v[208:223]
  ds_read_b64_tr_b16 v[110:111], v27 offset:27136
  v_add_f32 v29, v29, v45
  v_add_f32 v31, v31, v47
  s_waitcnt lgkmcnt(10)
  v_mfma_f32_32x32x16_bf16 v[160:175], v[88:91], a[0:3], v[160:175]
  ds_read_b64_tr_b16 v[80:81], v24 offset:28672
  buffer_load_dwordx4 a[40:43], v2, s[12:15], s54 offen offset:1024 sc1
  v_add_f32 v28, v28, v48
  v_add_f32 v30, v30, v50
  v_mfma_f32_32x32x16_bf16 v[224:239], v[88:91], a[4:7], v[224:239]
  ds_read_b64_tr_b16 v[82:83], v24 offset:29184
  buffer_load_dwordx4 a[44:47], v15, s[12:15], s54 offen offset:1024 sc1
  v_add_f32 v29, v29, v49
  v_add_f32 v31, v31, v51
  s_waitcnt lgkmcnt(10)
  v_mfma_f32_32x32x16_bf16 v[176:191], v[92:95], a[0:3], v[176:191]
  ds_read_b64_tr_b16 v[84:85], v25 offset:28672
  v_add_f32 v28, v28, v52
  v_add_f32 v30, v30, v54
  v_mfma_f32_32x32x16_bf16 v[240:255], v[92:95], a[4:7], v[240:255]
  ds_read_b64_tr_b16 v[86:87], v25 offset:29184
  buffer_load_dwordx4 a[48:51], v2, s[12:15], s54 offen offset:2048 sc1
  v_add_f32 v29, v29, v53
  v_add_f32 v31, v31, v55
  s_waitcnt lgkmcnt(10)
  v_mfma_f32_32x32x16_bf16 v[128:143], v[96:99], a[8:11], v[128:143]
  ds_read_b64_tr_b16 v[88:89], v26 offset:28672
  buffer_load_dwordx4 a[52:55], v15, s[12:15], s54 offen offset:2048 sc1
  v_permlane16_swap_b32 v28, v30
  v_permlane16_swap_b32 v29, v31
  v_mfma_f32_32x32x16_bf16 v[192:207], v[96:99], a[12:15], v[192:207]
  ds_read_b64_tr_b16 v[90:91], v26 offset:29184
  v_add_f32 v28, v28, v30
  v_add_f32 v29, v29, v31
  s_waitcnt lgkmcnt(10)
  v_mfma_f32_32x32x16_bf16 v[144:159], v[100:103], a[8:11], v[144:159]
  ds_read_b64_tr_b16 v[92:93], v27 offset:28672
  buffer_load_dwordx4 a[56:59], v2, s[12:15], s54 offen offset:3072 sc1
  v_mul_f32 v28, 0xbb124925, v28
  v_mul_f32 v29, 0x3b124925, v29
  v_mfma_f32_32x32x16_bf16 v[208:223], v[100:103], a[12:15], v[208:223]
  ds_read_b64_tr_b16 v[94:95], v27 offset:29184
  buffer_load_dwordx4 a[60:63], v15, s[12:15], s54 offen offset:3072 sc1
  s_add_u32 s54, s54, 4096
  s_cmp_eq_u32 s54, s52
  s_cselect_b32 s54, s55, s54
  v_fma_f32 v29, -v28, v28, v29
  v_max_f32 v29, 0, v29
  s_waitcnt lgkmcnt(10)
  v_mfma_f32_32x32x16_bf16 v[160:175], v[104:107], a[8:11], v[160:175]
  ds_read_b64_tr_b16 v[96:97], v24 offset:30720
  v_add_f32 v29, 0x3727c5ac, v29
  v_rcp_f32 v8, v29
  v_mfma_f32_32x32x16_bf16 v[224:239], v[104:107], a[12:15], v[224:239]
  ds_read_b64_tr_b16 v[98:99], v24 offset:31232
  buffer_load_dwordx4 a[64:67], v2, s[12:15], s54 offen offset:0 sc1
  v_cvt_pk_bf16_f32 v56, v28, v28
  v_lshlrev_b32 v31, 16, v56
  s_waitcnt lgkmcnt(10)
  v_mfma_f32_32x32x16_bf16 v[176:191], v[108:111], a[8:11], v[176:191]
  ds_read_b64_tr_b16 v[100:101], v25 offset:30720
  buffer_load_dwordx4 a[68:71], v15, s[12:15], s54 offen offset:0 sc1
  v_sub_f32 v31, v28, v31
  v_mov_b32 v10, v8
  v_mfma_f32_32x32x16_bf16 v[240:255], v[108:111], a[12:15], v[240:255]
  ds_read_b64_tr_b16 v[102:103], v25 offset:31232
  v_cvt_pk_bf16_f32 v57, v31, v31
  v_permlane32_swap_b32 v8, v10
  s_waitcnt lgkmcnt(10)
  v_mfma_f32_32x32x16_bf16 v[128:143], v[80:83], a[16:19], v[128:143]
  ds_read_b64_tr_b16 v[104:105], v26 offset:30720
  buffer_load_dwordx4 a[72:75], v2, s[12:15], s54 offen offset:1024 sc1
  v_permlane32_swap_b32 v56, v60
  v_permlane32_swap_b32 v57, v61
  v_mfma_f32_32x32x16_bf16 v[192:207], v[80:83], a[20:23], v[192:207]
  ds_read_b64_tr_b16 v[106:107], v26 offset:31232
  buffer_load_dwordx4 a[76:79], v15, s[12:15], s54 offen offset:1024 sc1
  s_waitcnt vmcnt(20)
  ds_read_b64_tr_b16 a[96:97], v78 offset:0
  s_waitcnt lgkmcnt(11)
  v_mfma_f32_32x32x16_bf16 v[144:159], v[84:87], a[16:19], v[144:159]
  ds_read_b64_tr_b16 v[108:109], v27 offset:30720
  ds_read_b64_tr_b16 a[98:99], v78 offset:512
  v_mfma_f32_32x32x16_bf16 v[208:223], v[84:87], a[20:23], v[208:223]
  ds_read_b64_tr_b16 v[110:111], v27 offset:31232
  buffer_load_dwordx4 a[80:83], v2, s[12:15], s54 offen offset:2048 sc1
  ds_read_b64_tr_b16 a[100:101], v79 offset:0
  s_waitcnt lgkmcnt(13)
  v_mfma_f32_32x32x16_bf16 v[160:175], v[88:91], a[16:19], v[160:175]
  ds_read_b64_tr_b16 v[80:81], v24 offset:32768
  buffer_load_dwordx4 a[84:87], v15, s[12:15], s54 offen offset:2048 sc1
  ds_read_b64_tr_b16 a[102:103], v79 offset:512
  v_mfma_f32_32x32x16_bf16 v[224:239], v[88:91], a[20:23], v[224:239]
  ds_read_b64_tr_b16 v[82:83], v24 offset:33280
  s_waitcnt vmcnt(20)
  ds_read_b64_tr_b16 a[104:105], v78 offset:2048
  s_waitcnt lgkmcnt(15)
  v_mfma_f32_32x32x16_bf16 v[176:191], v[92:95], a[16:19], v[176:191]
  ds_read_b64_tr_b16 v[84:85], v25 offset:32768
  buffer_load_dwordx4 a[88:91], v2, s[12:15], s54 offen offset:3072 sc1
  ds_read_b64_tr_b16 a[106:107], v78 offset:2560
  v_mfma_f32_32x32x16_bf16 v[240:255], v[92:95], a[20:23], v[240:255]
  ds_read_b64_tr_b16 v[86:87], v25 offset:33280
  buffer_load_dwordx4 a[92:95], v15, s[12:15], s54 offen offset:3072 sc1
  s_add_u32 s54, s54, 4096
  s_cmp_eq_u32 s54, s52
  s_cselect_b32 s54, s55, s54
  ds_read_b64_tr_b16 a[108:109], v79 offset:2048
  s_waitcnt lgkmcnt(15)
  v_mfma_f32_32x32x16_bf16 v[128:143], v[96:99], a[24:27], v[128:143]
  ds_read_b64_tr_b16 v[88:89], v26 offset:32768
  ds_read_b64_tr_b16 a[110:111], v79 offset:2560
  v_mfma_f32_32x32x16_bf16 v[192:207], v[96:99], a[28:31], v[192:207]
  ds_read_b64_tr_b16 v[90:91], v26 offset:33280
  buffer_load_dwordx4 a[0:3], v2, s[12:15], s54 offen offset:0 sc1
  s_waitcnt vmcnt(21)
  ds_read_b64_tr_b16 a[112:113], v78 offset:4096
  s_waitcnt lgkmcnt(15)
  v_mfma_f32_32x32x16_bf16 v[144:159], v[100:103], a[24:27], v[144:159]
  ds_read_b64_tr_b16 v[92:93], v27 offset:32768
  buffer_load_dwordx4 a[4:7], v15, s[12:15], s54 offen offset:0 sc1
  ds_read_b64_tr_b16 a[114:115], v78 offset:4608
  v_mfma_f32_32x32x16_bf16 v[208:223], v[100:103], a[28:31], v[208:223]
  ds_read_b64_tr_b16 v[94:95], v27 offset:33280
  ds_read_b64_tr_b16 a[116:117], v79 offset:4096
  s_waitcnt lgkmcnt(15)
  v_mfma_f32_32x32x16_bf16 v[160:175], v[104:107], a[24:27], v[160:175]
  ds_read_b64_tr_b16 v[96:97], v24 offset:34816
  buffer_load_dwordx4 a[8:11], v2, s[12:15], s54 offen offset:1024 sc1
  ds_read_b64_tr_b16 a[118:119], v79 offset:4608
  v_mfma_f32_32x32x16_bf16 v[224:239], v[104:107], a[28:31], v[224:239]
  ds_read_b64_tr_b16 v[98:99], v24 offset:35328
  buffer_load_dwordx4 a[12:15], v15, s[12:15], s54 offen offset:1024 sc1
  s_waitcnt vmcnt(22)
  ds_read_b64_tr_b16 a[120:121], v78 offset:6144
  s_waitcnt lgkmcnt(15)
  v_mfma_f32_32x32x16_bf16 v[176:191], v[108:111], a[24:27], v[176:191]
  ds_read_b64_tr_b16 v[100:101], v25 offset:34816
  ds_read_b64_tr_b16 a[122:123], v78 offset:6656
  v_mfma_f32_32x32x16_bf16 v[240:255], v[108:111], a[28:31], v[240:255]
  ds_read_b64_tr_b16 v[102:103], v25 offset:35328
  buffer_load_dwordx4 a[16:19], v2, s[12:15], s54 offen offset:2048 sc1
  ds_read_b64_tr_b16 a[124:125], v79 offset:6144
  s_waitcnt lgkmcnt(15)
  v_mfma_f32_32x32x16_bf16 v[128:143], v[80:83], a[32:35], v[128:143]
  ds_read_b64_tr_b16 v[104:105], v26 offset:34816
  buffer_load_dwordx4 a[20:23], v15, s[12:15], s54 offen offset:2048 sc1
  ds_read_b64_tr_b16 a[126:127], v79 offset:6656
  v_mfma_f32_32x32x16_bf16 v[192:207], v[80:83], a[36:39], v[192:207]
  ds_read_b64_tr_b16 v[106:107], v26 offset:35328
  s_waitcnt vmcnt(22)
  ds_read_b64_tr_b16 a[128:129], v78 offset:8192
  s_waitcnt lgkmcnt(15)
  v_mfma_f32_32x32x16_bf16 v[144:159], v[84:87], a[32:35], v[144:159]
  ds_read_b64_tr_b16 v[108:109], v27 offset:34816
  buffer_load_dwordx4 a[24:27], v2, s[12:15], s54 offen offset:3072 sc1
  ds_read_b64_tr_b16 a[130:131], v78 offset:8704
  v_mfma_f32_32x32x16_bf16 v[208:223], v[84:87], a[36:39], v[208:223]
  ds_read_b64_tr_b16 v[110:111], v27 offset:35328
  buffer_load_dwordx4 a[28:31], v15, s[12:15], s54 offen offset:3072 sc1
  s_add_u32 s54, s54, 4096
  s_cmp_eq_u32 s54, s52
  s_cselect_b32 s54, s55, s54
  ds_read_b64_tr_b16 a[132:133], v79 offset:8192
  s_waitcnt lgkmcnt(15)
  v_mfma_f32_32x32x16_bf16 v[160:175], v[88:91], a[32:35], v[160:175]
  ds_read_b64_tr_b16 v[80:81], v24 offset:36864
  ds_read_b64_tr_b16 a[134:135], v79 offset:8704
  v_mfma_f32_32x32x16_bf16 v[224:239], v[88:91], a[36:39], v[224:239]
  ds_read_b64_tr_b16 v[82:83], v24 offset:37376
  s_add_u32 m0, s19, 0
  s_nop 0
  buffer_load_dwordx4 v76, s[32:35], s16 offen lds
  s_waitcnt vmcnt(23)
  ds_read_b64_tr_b16 a[136:137], v78 offset:10240
  s_waitcnt lgkmcnt(15)
  v_mfma_f32_32x32x16_bf16 v[176:191], v[92:95], a[32:35], v[176:191]
  ds_read_b64_tr_b16 v[84:85], v25 offset:36864
  buffer_load_dwordx4 v77, s[32:35], s16 offen offset:1024 lds
  s_add_u32 s16, s16, 14336
  ds_read_b64_tr_b16 a[138:139], v78 offset:10752
  v_mfma_f32_32x32x16_bf16 v[240:255], v[92:95], a[36:39], v[240:255]
  ds_read_b64_tr_b16 v[86:87], v25 offset:37376
  ds_read_b64_tr_b16 a[140:141], v79 offset:10240
  s_waitcnt vmcnt(23) lgkmcnt(15)
  v_mfma_f32_32x32x16_bf16 v[128:143], v[96:99], a[40:43], v[128:143]
  ds_read_b64_tr_b16 v[88:89], v26 offset:36864
  s_add_u32 m0, s19, 2048
  s_nop 0
  buffer_load_dwordx4 v76, s[32:35], s16 offen lds
  ds_read_b64_tr_b16 a[142:143], v79 offset:10752
  s_waitcnt vmcnt(23)
  v_mfma_f32_32x32x16_bf16 v[192:207], v[96:99], a[44:47], v[192:207]
  ds_read_b64_tr_b16 v[90:91], v26 offset:37376
  buffer_load_dwordx4 v77, s[32:35], s16 offen offset:1024 lds
  s_add_u32 s16, s16, 14336
  s_cmp_eq_u32 s16, s18
  s_cselect_b32 s16, s17, s16
  s_waitcnt lgkmcnt(15)
  v_mfma_f32_32x32x16_bf16 v[144:159], v[100:103], a[40:43], v[144:159]
  ds_read_b64_tr_b16 v[92:93], v27 offset:36864
  v_mfma_f32_32x32x16_bf16 v[208:223], v[100:103], a[44:47], v[208:223]
  ds_read_b64_tr_b16 v[94:95], v27 offset:37376
  s_add_u32 m0, s19, 4096
  s_nop 0
  buffer_load_dwordx4 v76, s[32:35], s16 offen lds
  s_waitcnt lgkmcnt(15)
  v_mfma_f32_32x32x16_bf16 v[160:175], v[104:107], a[40:43], v[160:175]
  ds_read_b64_tr_b16 v[96:97], v24 offset:38912
  buffer_load_dwordx4 v77, s[32:35], s16 offen offset:1024 lds
  s_add_u32 s16, s16, 14336
  v_mfma_f32_32x32x16_bf16 v[224:239], v[104:107], a[44:47], v[224:239]
  ds_read_b64_tr_b16 v[98:99], v24 offset:39424
  s_waitcnt lgkmcnt(15)
  v_mfma_f32_32x32x16_bf16 v[176:191], v[108:111], a[40:43], v[176:191]
  ds_read_b64_tr_b16 v[100:101], v25 offset:38912
  s_add_u32 m0, s19, 6144
  s_nop 0
  buffer_load_dwordx4 v76, s[32:35], s16 offen lds
  v_mfma_f32_32x32x16_bf16 v[240:255], v[108:111], a[44:47], v[240:255]
  ds_read_b64_tr_b16 v[102:103], v25 offset:39424
  buffer_load_dwordx4 v77, s[32:35], s16 offen offset:1024 lds
  s_add_u32 s16, s16, 14336
  s_waitcnt vmcnt(27) lgkmcnt(14)
  v_mfma_f32_32x32x16_bf16 v[128:143], v[80:83], a[48:51], v[128:143]
  ds_read_b64_tr_b16 v[104:105], v26 offset:38912
  s_waitcnt vmcnt(26)
  v_mfma_f32_32x32x16_bf16 v[192:207], v[80:83], a[52:55], v[192:207]
  ds_read_b64_tr_b16 v[106:107], v26 offset:39424
  s_add_u32 m0, s19, 8192
  s_nop 0
  buffer_load_dwordx4 v76, s[32:35], s16 offen lds
  s_waitcnt lgkmcnt(12)
  v_mfma_f32_32x32x16_bf16 v[144:159], v[84:87], a[48:51], v[144:159]
  ds_read_b64_tr_b16 v[108:109], v27 offset:38912
  buffer_load_dwordx4 v77, s[32:35], s16 offen offset:1024 lds
  s_add_u32 s16, s16, 14336
  v_mfma_f32_32x32x16_bf16 v[208:223], v[84:87], a[52:55], v[208:223]
  ds_read_b64_tr_b16 v[110:111], v27 offset:39424
  s_waitcnt lgkmcnt(10)
  v_mfma_f32_32x32x16_bf16 v[160:175], v[88:91], a[48:51], v[160:175]
  ds_read_b64_tr_b16 v[80:81], v24 offset:40960
  s_add_u32 m0, s19, 10240
  s_nop 0
  buffer_load_dwordx4 v76, s[32:35], s16 offen lds
  v_mfma_f32_32x32x16_bf16 v[224:239], v[88:91], a[52:55], v[224:239]
  ds_read_b64_tr_b16 v[82:83], v24 offset:41472
  buffer_load_dwordx4 v77, s[32:35], s16 offen offset:1024 lds
  s_add_u32 s16, s16, 14336
  s_cmp_eq_u32 s16, s18
  s_cselect_b32 s16, s17, s16
  s_waitcnt lgkmcnt(10)
  v_mfma_f32_32x32x16_bf16 v[176:191], v[92:95], a[48:51], v[176:191]
  ds_read_b64_tr_b16 v[84:85], v24 offset:43008
  v_mfma_f32_32x32x16_bf16 v[240:255], v[92:95], a[52:55], v[240:255]
  ds_read_b64_tr_b16 v[86:87], v24 offset:43520
  s_waitcnt vmcnt(29) lgkmcnt(10)
  v_mfma_f32_32x32x16_bf16 v[128:143], v[96:99], a[56:59], v[128:143]
  ds_read_b64_tr_b16 v[88:89], v24 offset:45056
  s_waitcnt vmcnt(28)
  v_mfma_f32_32x32x16_bf16 v[192:207], v[96:99], a[60:63], v[192:207]
  ds_read_b64_tr_b16 v[90:91], v24 offset:45568
  s_waitcnt vmcnt(10)
  ds_read_b64_tr_b16 a[144:145], v78 offset:0
  s_waitcnt lgkmcnt(11)
  v_mfma_f32_32x32x16_bf16 v[144:159], v[100:103], a[56:59], v[144:159]
  ds_read_b64_tr_b16 v[92:93], v24 offset:47104
  ds_read_b64_tr_b16 a[146:147], v78 offset:512
  v_mfma_f32_32x32x16_bf16 v[208:223], v[100:103], a[60:63], v[208:223]
  ds_read_b64_tr_b16 v[94:95], v24 offset:47616
  ds_read_b64_tr_b16 a[148:149], v79 offset:0
  s_waitcnt lgkmcnt(13)
  v_mfma_f32_32x32x16_bf16 v[160:175], v[104:107], a[56:59], v[160:175]
  ds_read_b64_tr_b16 v[96:97], v24 offset:49152
  ds_read_b64_tr_b16 a[150:151], v79 offset:512
  v_mfma_f32_32x32x16_bf16 v[224:239], v[104:107], a[60:63], v[224:239]
  ds_read_b64_tr_b16 v[98:99], v24 offset:49664
  s_waitcnt vmcnt(8)
  ds_read_b64_tr_b16 a[152:153], v78 offset:2048
  s_waitcnt lgkmcnt(15)
  v_mfma_f32_32x32x16_bf16 v[176:191], v[108:111], a[56:59], v[176:191]
  ds_read_b64_tr_b16 v[100:101], v24 offset:51200
  ds_read_b64_tr_b16 a[154:155], v78 offset:2560
  v_mfma_f32_32x32x16_bf16 v[240:255], v[108:111], a[60:63], v[240:255]
  ds_read_b64_tr_b16 v[102:103], v24 offset:51712
  s_waitcnt lgkmcnt(5)
  s_add_u32 m0, s19, 0
  s_nop 0
  buffer_load_dwordx4 v76, s[32:35], s16 offen lds
  ds_read_b64_tr_b16 a[156:157], v79 offset:2048
  v_mfma_f32_32x32x16_bf16 v[128:143], v[80:83], a[64:67], v[128:143]
  ds_read_b64_tr_b16 v[104:105], v24 offset:53248
  buffer_load_dwordx4 v77, s[32:35], s16 offen offset:1024 lds
  s_add_u32 s16, s16, 14336
  ds_read_b64_tr_b16 a[158:159], v79 offset:2560
  v_mfma_f32_32x32x16_bf16 v[192:207], v[80:83], a[68:71], v[192:207]
  ds_read_b64_tr_b16 v[106:107], v24 offset:53760
  s_waitcnt vmcnt(8)
  ds_read_b64_tr_b16 a[160:161], v78 offset:4096
  v_mfma_f32_32x32x16_bf16 v[128:143], v[84:87], a[72:75], v[128:143]
  ds_read_b64_tr_b16 v[108:109], v24 offset:55296
  ds_read_b64_tr_b16 a[162:163], v78 offset:4608
  v_mfma_f32_32x32x16_bf16 v[192:207], v[84:87], a[76:79], v[192:207]
  ds_read_b64_tr_b16 v[110:111], v24 offset:55808
  s_waitcnt lgkmcnt(5)
  s_add_u32 m0, s19, 2048
  s_nop 0
  buffer_load_dwordx4 v76, s[32:35], s16 offen lds
  ds_read_b64_tr_b16 a[164:165], v79 offset:4096
  v_mfma_f32_32x32x16_bf16 v[128:143], v[88:91], a[80:83], v[128:143]
  ds_read_b64_tr_b16 v[80:81], v25 offset:40960
  buffer_load_dwordx4 v77, s[32:35], s16 offen offset:1024 lds
  s_add_u32 s16, s16, 14336
  ds_read_b64_tr_b16 a[166:167], v79 offset:4608
  v_mfma_f32_32x32x16_bf16 v[192:207], v[88:91], a[84:87], v[192:207]
  ds_read_b64_tr_b16 v[82:83], v25 offset:41472
  s_waitcnt vmcnt(8)
  ds_read_b64_tr_b16 a[168:169], v78 offset:6144
  v_mfma_f32_32x32x16_bf16 v[128:143], v[92:95], a[88:91], v[128:143]
  ds_read_b64_tr_b16 v[84:85], v25 offset:43008
  ds_read_b64_tr_b16 a[170:171], v78 offset:6656
  v_mfma_f32_32x32x16_bf16 v[192:207], v[92:95], a[92:95], v[192:207]
  ds_read_b64_tr_b16 v[86:87], v25 offset:43520
  s_waitcnt lgkmcnt(5)
  s_add_u32 m0, s19, 4096
  s_nop 0
  buffer_load_dwordx4 v76, s[32:35], s16 offen lds
  ds_read_b64_tr_b16 a[172:173], v79 offset:6144
  v_mfma_f32_32x32x16_bf16 v[128:143], v[112:115], v[56:59], v[128:143]
  buffer_load_dwordx4 v77, s[32:35], s16 offen offset:1024 lds
  s_add_u32 s16, s16, 14336
  ds_read_b64_tr_b16 a[174:175], v79 offset:6656
  v_mfma_f32_32x32x16_bf16 v[192:207], v[112:115], v[60:63], v[192:207]
  s_waitcnt vmcnt(8)
  ds_read_b64_tr_b16 a[176:177], v78 offset:8192
  v_mfma_f32_32x32x16_bf16 v[128:143], v[96:99], a[0:3], v[128:143]
  ds_read_b64_tr_b16 v[88:89], v25 offset:45056
  ds_read_b64_tr_b16 a[178:179], v78 offset:8704
  v_mfma_f32_32x32x16_bf16 v[192:207], v[96:99], a[4:7], v[192:207]
  ds_read_b64_tr_b16 v[90:91], v25 offset:45568
  s_waitcnt lgkmcnt(4)
  s_add_u32 m0, s19, 6144
  s_nop 0
  buffer_load_dwordx4 v76, s[32:35], s16 offen lds
  ds_read_b64_tr_b16 a[180:181], v79 offset:8192
  v_mfma_f32_32x32x16_bf16 v[128:143], v[100:103], a[8:11], v[128:143]
  ds_read_b64_tr_b16 v[92:93], v25 offset:47104
  buffer_load_dwordx4 v77, s[32:35], s16 offen offset:1024 lds
  s_add_u32 s16, s16, 14336
  s_cmp_eq_u32 s16, s18
  s_cselect_b32 s16, s17, s16
  ds_read_b64_tr_b16 a[182:183], v79 offset:8704
  v_mfma_f32_32x32x16_bf16 v[192:207], v[100:103], a[12:15], v[192:207]
  ds_read_b64_tr_b16 v[94:95], v25 offset:47616
  s_waitcnt vmcnt(8)
  ds_read_b64_tr_b16 a[184:185], v78 offset:10240
  v_mfma_f32_32x32x16_bf16 v[128:143], v[104:107], a[16:19], v[128:143]
  ds_read_b64_tr_b16 v[96:97], v25 offset:49152
  ds_read_b64_tr_b16 a[186:187], v78 offset:10752
  v_mfma_f32_32x32x16_bf16 v[192:207], v[104:107], a[20:23], v[192:207]
  ds_read_b64_tr_b16 v[98:99], v25 offset:49664
  s_waitcnt lgkmcnt(5)
  s_add_u32 m0, s19, 8192
  s_nop 0
  buffer_load_dwordx4 v76, s[32:35], s16 offen lds
  ds_read_b64_tr_b16 a[188:189], v79 offset:10240
  v_mfma_f32_32x32x16_bf16 v[128:143], v[108:111], a[24:27], v[128:143]
  ds_read_b64_tr_b16 v[100:101], v25 offset:51200
  buffer_load_dwordx4 v77, s[32:35], s16 offen offset:1024 lds
  s_add_u32 s16, s16, 14336
  ds_read_b64_tr_b16 a[190:191], v79 offset:10752
  v_mfma_f32_32x32x16_bf16 v[192:207], v[108:111], a[28:31], v[192:207]
  ds_read_b64_tr_b16 v[102:103], v25 offset:51712
  v_mfma_f32_32x32x16_bf16 v[144:159], v[80:83], a[64:67], v[144:159]
  ds_read_b64_tr_b16 v[104:105], v25 offset:53248
  v_mfma_f32_32x32x16_bf16 v[208:223], v[80:83], a[68:71], v[208:223]
  ds_read_b64_tr_b16 v[106:107], v25 offset:53760
  s_waitcnt lgkmcnt(3)
  s_add_u32 m0, s19, 10240
  s_nop 0
  buffer_load_dwordx4 v76, s[32:35], s16 offen lds
  s_waitcnt vmcnt(9)
  ds_read_b64_tr_b16 a[192:193], v78 offset:0
  v_mfma_f32_32x32x16_bf16 v[144:159], v[84:87], a[72:75], v[144:159]
  ds_read_b64_tr_b16 v[108:109], v25 offset:55296
  buffer_load_dwordx4 v77, s[32:35], s16 offen offset:1024 lds
  s_add_u32 s16, s16, 14336
  ds_read_b64_tr_b16 a[194:195], v78 offset:512
  v_mul_f32 v128, v128, v136
  v_mul_f32 v129, v129, v137
  v_mul_f32 v130, v130, v138
  v_mfma_f32_32x32x16_bf16 v[208:223], v[84:87], a[76:79], v[208:223]
  ds_read_b64_tr_b16 v[110:111], v25 offset:55808
  ds_read_b64_tr_b16 a[196:197], v79 offset:0
  v_mul_f32 v131, v131, v139
  v_mul_f32 v132, v132, v140
  v_mul_f32 v133, v133, v141
  v_mfma_f32_32x32x16_bf16 v[144:159], v[88:91], a[80:83], v[144:159]
  ds_read_b64_tr_b16 v[80:81], v26 offset:40960
  ds_read_b64_tr_b16 a[198:199], v79 offset:512
  v_mul_f32 v134, v134, v142
  v_mul_f32 v135, v135, v143
  v_mul_f32 v128, v128, v8
  v_mfma_f32_32x32x16_bf16 v[208:223], v[88:91], a[84:87], v[208:223]
  ds_read_b64_tr_b16 v[82:83], v26 offset:41472
  s_waitcnt vmcnt(8)
  ds_read_b64_tr_b16 a[200:201], v78 offset:2048
  v_mul_f32 v129, v129, v8
  v_mul_f32 v130, v130, v8
  v_mul_f32 v131, v131, v8
  v_mfma_f32_32x32x16_bf16 v[144:159], v[92:95], a[88:91], v[144:159]
  ds_read_b64_tr_b16 v[84:85], v26 offset:43008
  ds_read_b64_tr_b16 a[202:203], v78 offset:2560
  v_mul_f32 v132, v132, v8
  v_mul_f32 v133, v133, v8
  v_mul_f32 v134, v134, v8
  v_mfma_f32_32x32x16_bf16 v[208:223], v[92:95], a[92:95], v[208:223]
  ds_read_b64_tr_b16 v[86:87], v26 offset:43520
  s_waitcnt lgkmcnt(5)
  s_add_u32 m0, s19, 0
  s_nop 0
  buffer_load_dwordx4 v76, s[32:35], s16 offen lds
  ds_read_b64_tr_b16 a[204:205], v79 offset:2048
  v_mul_f32 v135, v135, v8
  v_cvt_pk_bf16_f32 v136, v128, v129
  v_cvt_pk_bf16_f32 v137, v130, v131
  v_mfma_f32_32x32x16_bf16 v[144:159], v[114:117], v[56:59], v[144:159]
  buffer_load_dwordx4 v77, s[32:35], s16 offen offset:1024 lds
  s_add_u32 s16, s16, 14336
  ds_read_b64_tr_b16 a[206:207], v79 offset:2560
  v_cvt_pk_bf16_f32 v138, v132, v133
  v_cvt_pk_bf16_f32 v139, v134, v135
  buffer_store_dwordx4 v[136:139], v2, s[12:15], s58 offen offset:0 sc1
  v_mfma_f32_32x32x16_bf16 v[208:223], v[114:117], v[60:63], v[208:223]
  s_waitcnt vmcnt(9)
  ds_read_b64_tr_b16 a[208:209], v78 offset:4096
  v_mul_f32 v192, v192, v200
  v_mul_f32 v193, v193, v201
  v_mul_f32 v194, v194, v202
  v_mfma_f32_32x32x16_bf16 v[144:159], v[96:99], a[0:3], v[144:159]
  ds_read_b64_tr_b16 v[88:89], v26 offset:45056
  ds_read_b64_tr_b16 a[210:211], v78 offset:4608
  v_mul_f32 v195, v195, v203
  v_mul_f32 v196, v196, v204
  v_mul_f32 v197, v197, v205
  v_mfma_f32_32x32x16_bf16 v[208:223], v[96:99], a[4:7], v[208:223]
  ds_read_b64_tr_b16 v[90:91], v26 offset:45568
  s_waitcnt lgkmcnt(4)
  s_add_u32 m0, s19, 2048
  s_nop 0
  buffer_load_dwordx4 v76, s[32:35], s16 offen lds
  ds_read_b64_tr_b16 a[212:213], v79 offset:4096
  v_mul_f32 v198, v198, v206
  v_mul_f32 v199, v199, v207
  v_mul_f32 v192, v192, v10
  v_mfma_f32_32x32x16_bf16 v[144:159], v[100:103], a[8:11], v[144:159]
  ds_read_b64_tr_b16 v[92:93], v26 offset:47104
  buffer_load_dwordx4 v77, s[32:35], s16 offen offset:1024 lds
  s_add_u32 s16, s16, 14336
  s_cmp_eq_u32 s16, s18
  s_cselect_b32 s16, s17, s16
  ds_read_b64_tr_b16 a[214:215], v79 offset:4608
  v_mul_f32 v193, v193, v10
  v_mul_f32 v194, v194, v10
  v_mul_f32 v195, v195, v10
  v_mfma_f32_32x32x16_bf16 v[208:223], v[100:103], a[12:15], v[208:223]
  ds_read_b64_tr_b16 v[94:95], v26 offset:47616
  s_waitcnt vmcnt(9)
  ds_read_b64_tr_b16 a[216:217], v78 offset:6144
  v_mul_f32 v196, v196, v10
  v_mul_f32 v197, v197, v10
  v_mul_f32 v198, v198, v10
  v_mfma_f32_32x32x16_bf16 v[144:159], v[104:107], a[16:19], v[144:159]
  ds_read_b64_tr_b16 v[96:97], v26 offset:49152
  ds_read_b64_tr_b16 a[218:219], v78 offset:6656
  v_mul_f32 v199, v199, v10
  v_cvt_pk_bf16_f32 v200, v192, v193
  v_cvt_pk_bf16_f32 v201, v194, v195
  v_mfma_f32_32x32x16_bf16 v[208:223], v[104:107], a[20:23], v[208:223]
  ds_read_b64_tr_b16 v[98:99], v26 offset:49664
  s_waitcnt lgkmcnt(5)
  s_add_u32 m0, s19, 4096
  s_nop 0
  buffer_load_dwordx4 v76, s[32:35], s16 offen lds
  ds_read_b64_tr_b16 a[220:221], v79 offset:6144
  v_cvt_pk_bf16_f32 v202, v196, v197
  v_cvt_pk_bf16_f32 v203, v198, v199
  buffer_store_dwordx4 v[200:203], v2, s[12:15], s59 offen offset:0 sc1
  v_mfma_f32_32x32x16_bf16 v[144:159], v[108:111], a[24:27], v[144:159]
  ds_read_b64_tr_b16 v[100:101], v26 offset:51200
  buffer_load_dwordx4 v77, s[32:35], s16 offen offset:1024 lds
  s_add_u32 s16, s16, 14336
  ds_read_b64_tr_b16 a[222:223], v79 offset:6656
  v_mfma_f32_32x32x16_bf16 v[208:223], v[108:111], a[28:31], v[208:223]
  ds_read_b64_tr_b16 v[102:103], v26 offset:51712
  s_waitcnt vmcnt(10)
  ds_read_b64_tr_b16 a[224:225], v78 offset:8192
  v_mfma_f32_32x32x16_bf16 v[160:175], v[80:83], a[64:67], v[160:175]
  ds_read_b64_tr_b16 v[104:105], v26 offset:53248
  ds_read_b64_tr_b16 a[226:227], v78 offset:8704
  v_mfma_f32_32x32x16_bf16 v[224:239], v[80:83], a[68:71], v[224:239]
  ds_read_b64_tr_b16 v[106:107], v26 offset:53760
  s_waitcnt lgkmcnt(5)
  s_add_u32 m0, s19, 6144
  s_nop 0
  buffer_load_dwordx4 v76, s[32:35], s16 offen lds
  ds_read_b64_tr_b16 a[228:229], v79 offset:8192
  v_mfma_f32_32x32x16_bf16 v[160:175], v[84:87], a[72:75], v[160:175]
  ds_read_b64_tr_b16 v[108:109], v26 offset:55296
  buffer_load_dwordx4 v77, s[32:35], s16 offen offset:1024 lds
  s_add_u32 s16, s16, 14336
  ds_read_b64_tr_b16 a[230:231], v79 offset:8704
  v_mul_f32 v144, v144, v152
  v_mul_f32 v145, v145, v153
  v_mul_f32 v146, v146, v154
  v_mfma_f32_32x32x16_bf16 v[224:239], v[84:87], a[76:79], v[224:239]
  ds_read_b64_tr_b16 v[110:111], v26 offset:55808
  s_waitcnt vmcnt(10)
  ds_read_b64_tr_b16 a[232:233], v78 offset:10240
  v_mul_f32 v147, v147, v155
  v_mul_f32 v148, v148, v156
  v_mul_f32 v149, v149, v157
  v_mfma_f32_32x32x16_bf16 v[160:175], v[88:91], a[80:83], v[160:175]
  ds_read_b64_tr_b16 v[80:81], v27 offset:40960
  ds_read_b64_tr_b16 a[234:235], v78 offset:10752
  v_mul_f32 v150, v150, v158
  v_mul_f32 v151, v151, v159
  v_mul_f32 v144, v144, v8
  v_mfma_f32_32x32x16_bf16 v[224:239], v[88:91], a[84:87], v[224:239]
  ds_read_b64_tr_b16 v[82:83], v27 offset:41472
  ds_read_b64_tr_b16 a[236:237], v79 offset:10240
  v_mul_f32 v145, v145, v8
  v_mul_f32 v146, v146, v8
  v_mul_f32 v147, v147, v8
  v_mfma_f32_32x32x16_bf16 v[160:175], v[92:95], a[88:91], v[160:175]
  ds_read_b64_tr_b16 v[84:85], v27 offset:43008
  ds_read_b64_tr_b16 a[238:239], v79 offset:10752
  v_mul_f32 v148, v148, v8
  v_mul_f32 v149, v149, v8
  v_mul_f32 v150, v150, v8
  v_mfma_f32_32x32x16_bf16 v[224:239], v[92:95], a[92:95], v[224:239]
  ds_read_b64_tr_b16 v[86:87], v27 offset:43520
  v_mul_f32 v151, v151, v8
  v_cvt_pk_bf16_f32 v152, v144, v145
  v_cvt_pk_bf16_f32 v153, v146, v147
  v_mfma_f32_32x32x16_bf16 v[160:175], v[116:119], v[56:59], v[160:175]
  v_cvt_pk_bf16_f32 v154, v148, v149
  v_cvt_pk_bf16_f32 v155, v150, v151
  buffer_store_dwordx4 v[152:155], v2, s[12:15], s58 offen offset:1024 sc1
  v_mfma_f32_32x32x16_bf16 v[224:239], v[116:119], v[60:63], v[224:239]
  s_waitcnt vmcnt(9)
  ds_read_b64_tr_b16 a[240:241], v78 offset:0
  v_mul_f32 v208, v208, v216
  v_mul_f32 v209, v209, v217
  v_mul_f32 v210, v210, v218
  v_mfma_f32_32x32x16_bf16 v[160:175], v[96:99], a[0:3], v[160:175]
  ds_read_b64_tr_b16 v[88:89], v27 offset:45056
  ds_read_b64_tr_b16 a[242:243], v78 offset:512
  v_mul_f32 v211, v211, v219
  v_mul_f32 v212, v212, v220
  v_mul_f32 v213, v213, v221
  v_mfma_f32_32x32x16_bf16 v[224:239], v[96:99], a[4:7], v[224:239]
  s_branch L_ov5
  .p2align 12
L_pg5:
  s_branch L_bk2
L_ov5:
  ds_read_b64_tr_b16 v[90:91], v27 offset:45568
  ds_read_b64_tr_b16 a[244:245], v79 offset:0
  v_mul_f32 v214, v214, v222
  v_mul_f32 v215, v215, v223
  v_mul_f32 v208, v208, v10
  s_waitcnt lgkmcnt(15)
  v_mfma_f32_32x32x16_bf16 v[160:175], v[100:103], a[8:11], v[160:175]
  ds_read_b64_tr_b16 v[92:93], v27 offset:47104
  ds_read_b64_tr_b16 a[246:247], v79 offset:512
  v_mul_f32 v209, v209, v10
  v_mul_f32 v210, v210, v10
  v_mul_f32 v211, v211, v10
  v_mfma_f32_32x32x16_bf16 v[224:239], v[100:103], a[12:15], v[224:239]
  ds_read_b64_tr_b16 v[94:95], v27 offset:47616
  s_waitcnt vmcnt(6)
  ds_read_b64_tr_b16 a[248:249], v78 offset:2048
  v_mul_f32 v212, v212, v10
  v_mul_f32 v213, v213, v10
  v_mul_f32 v214, v214, v10
  s_waitcnt lgkmcnt(15)
  v_mfma_f32_32x32x16_bf16 v[160:175], v[104:107], a[16:19], v[160:175]
  ds_read_b64_tr_b16 v[96:97], v27 offset:49152
  ds_read_b64_tr_b16 a[250:251], v78 offset:2560
  v_mul_f32 v215, v215, v10
  v_cvt_pk_bf16_f32 v216, v208, v209
  v_cvt_pk_bf16_f32 v217, v210, v211
  v_mfma_f32_32x32x16_bf16 v[224:239], v[104:107], a[20:23], v[224:239]
  ds_read_b64_tr_b16 v[98:99], v27 offset:49664
  ds_read_b64_tr_b16 a[252:253], v79 offset:2048
  v_cvt_pk_bf16_f32 v218, v212, v213
  v_cvt_pk_bf16_f32 v219, v214, v215
  buffer_store_dwordx4 v[216:219], v2, s[12:15], s59 offen offset:1024 sc1
  s_waitcnt lgkmcnt(15)
  v_mfma_f32_32x32x16_bf16 v[160:175], v[108:111], a[24:27], v[160:175]
  ds_read_b64_tr_b16 v[100:101], v27 offset:51200
  ds_read_b64_tr_b16 a[254:255], v79 offset:2560
  v_mfma_f32_32x32x16_bf16 v[224:239], v[108:111], a[28:31], v[224:239]
  ds_read_b64_tr_b16 v[102:103], v27 offset:51712
  s_waitcnt vmcnt(4)
  ds_read_b64_tr_b16 a[32:33], v78 offset:4096
  s_waitcnt lgkmcnt(15)
  v_mfma_f32_32x32x16_bf16 v[176:191], v[80:83], a[64:67], v[176:191]
  ds_read_b64_tr_b16 v[104:105], v27 offset:53248
  ds_read_b64_tr_b16 a[34:35], v78 offset:4608
  v_mfma_f32_32x32x16_bf16 v[240:255], v[80:83], a[68:71], v[240:255]
  ds_read_b64_tr_b16 v[106:107], v27 offset:53760
  ds_read_b64_tr_b16 a[36:37], v79 offset:4096
  s_waitcnt lgkmcnt(15)
  v_mfma_f32_32x32x16_bf16 v[176:191], v[84:87], a[72:75], v[176:191]
  ds_read_b64_tr_b16 v[108:109], v27 offset:55296
  ds_read_b64_tr_b16 a[38:39], v79 offset:4608
  v_mul_f32 v160, v160, v168
  v_mul_f32 v161, v161, v169
  v_mul_f32 v162, v162, v170
  v_mfma_f32_32x32x16_bf16 v[240:255], v[84:87], a[76:79], v[240:255]
  ds_read_b64_tr_b16 v[110:111], v27 offset:55808
  s_waitcnt vmcnt(2)
  ds_read_b64_tr_b16 a[40:41], v78 offset:6144
  v_mul_f32 v163, v163, v171
  v_mul_f32 v164, v164, v172
  v_mul_f32 v165, v165, v173
  s_waitcnt lgkmcnt(15)
  v_mfma_f32_32x32x16_bf16 v[176:191], v[88:91], a[80:83], v[176:191]
  ds_read_b64_tr_b16 a[42:43], v78 offset:6656
  v_mul_f32 v166, v166, v174
  v_mul_f32 v167, v167, v175
  v_mul_f32 v160, v160, v8
  v_mfma_f32_32x32x16_bf16 v[240:255], v[88:91], a[84:87], v[240:255]
  ds_read_b64_tr_b16 a[44:45], v79 offset:6144
  v_mul_f32 v161, v161, v8
  v_mul_f32 v162, v162, v8
  v_mul_f32 v163, v163, v8
  s_waitcnt lgkmcnt(15)
  v_mfma_f32_32x32x16_bf16 v[176:191], v[92:95], a[88:91], v[176:191]
  ds_read_b64_tr_b16 a[46:47], v79 offset:6656
  v_mul_f32 v164, v164, v8
  v_mul_f32 v165, v165, v8
  v_mul_f32 v166, v166, v8
  v_mfma_f32_32x32x16_bf16 v[240:255], v[92:95], a[92:95], v[240:255]
  v_mul_f32 v167, v167, v8
  v_cvt_pk_bf16_f32 v168, v160, v161
  v_cvt_pk_bf16_f32 v169, v162, v163
  v_mfma_f32_32x32x16_bf16 v[176:191], v[118:121], v[56:59], v[176:191]
  v_cvt_pk_bf16_f32 v170, v164, v165
  v_cvt_pk_bf16_f32 v171, v166, v167
  buffer_store_dwordx4 v[168:171], v2, s[12:15], s58 offen offset:2048 sc1
  v_mfma_f32_32x32x16_bf16 v[240:255], v[118:121], v[60:63], v[240:255]
  v_mul_f32 v224, v224, v232
  v_mul_f32 v225, v225, v233
  v_mul_f32 v226, v226, v234
  s_waitcnt lgkmcnt(15)
  v_mfma_f32_32x32x16_bf16 v[176:191], v[96:99], a[0:3], v[176:191]
  v_mul_f32 v227, v227, v235
  v_mul_f32 v228, v228, v236
  v_mul_f32 v229, v229, v237
  v_mfma_f32_32x32x16_bf16 v[240:255], v[96:99], a[4:7], v[240:255]
  v_mul_f32 v230, v230, v238
  v_mul_f32 v231, v231, v239
  v_mul_f32 v224, v224, v10
  s_waitcnt lgkmcnt(12)
  v_mfma_f32_32x32x16_bf16 v[176:191], v[100:103], a[8:11], v[176:191]
  v_mul_f32 v225, v225, v10
  v_mul_f32 v226, v226, v10
  v_mul_f32 v227, v227, v10
  v_mfma_f32_32x32x16_bf16 v[240:255], v[100:103], a[12:15], v[240:255]
  v_mul_f32 v228, v228, v10
  v_mul_f32 v229, v229, v10
  v_mul_f32 v230, v230, v10
  s_waitcnt lgkmcnt(8)
  v_mfma_f32_32x32x16_bf16 v[176:191], v[104:107], a[16:19], v[176:191]
  v_mul_f32 v231, v231, v10
  v_cvt_pk_bf16_f32 v232, v224, v225
  v_cvt_pk_bf16_f32 v233, v226, v227
  v_mfma_f32_32x32x16_bf16 v[240:255], v[104:107], a[20:23], v[240:255]
  v_cvt_pk_bf16_f32 v234, v228, v229
  v_cvt_pk_bf16_f32 v235, v230, v231
  buffer_store_dwordx4 v[232:235], v2, s[12:15], s59 offen offset:2048 sc1
  s_waitcnt lgkmcnt(4)
  v_mfma_f32_32x32x16_bf16 v[176:191], v[108:111], a[24:27], v[176:191]
  v_mfma_f32_32x32x16_bf16 v[240:255], v[108:111], a[28:31], v[240:255]
  s_nop 10
  v_pk_mul_f32 v[176:177], v[176:177], v[184:185]
  v_pk_mul_f32 v[178:179], v[178:179], v[186:187]
  v_pk_mul_f32 v[180:181], v[180:181], v[188:189]
  v_pk_mul_f32 v[182:183], v[182:183], v[190:191]
  v_pk_mul_f32 v[176:177], v[176:177], v[8:9] op_sel_hi:[1,0]
  v_pk_mul_f32 v[178:179], v[178:179], v[8:9] op_sel_hi:[1,0]
  v_pk_mul_f32 v[180:181], v[180:181], v[8:9] op_sel_hi:[1,0]
  v_pk_mul_f32 v[182:183], v[182:183], v[8:9] op_sel_hi:[1,0]
  v_cvt_pk_bf16_f32 v184, v176, v177
  v_cvt_pk_bf16_f32 v185, v178, v179
  v_cvt_pk_bf16_f32 v186, v180, v181
  v_cvt_pk_bf16_f32 v187, v182, v183
  buffer_store_dwordx4 v[184:187], v2, s[12:15], s58 offen offset:3072 sc1
  v_pk_mul_f32 v[240:241], v[240:241], v[248:249]
  v_pk_mul_f32 v[242:243], v[242:243], v[250:251]
  v_pk_mul_f32 v[244:245], v[244:245], v[252:253]
  v_pk_mul_f32 v[246:247], v[246:247], v[254:255]
  v_pk_mul_f32 v[240:241], v[240:241], v[10:11] op_sel_hi:[1,0]
  v_pk_mul_f32 v[242:243], v[242:243], v[10:11] op_sel_hi:[1,0]
  v_pk_mul_f32 v[244:245], v[244:245], v[10:11] op_sel_hi:[1,0]
  v_pk_mul_f32 v[246:247], v[246:247], v[10:11] op_sel_hi:[1,0]
  v_cvt_pk_bf16_f32 v248, v240, v241
  v_cvt_pk_bf16_f32 v249, v242, v243
  v_cvt_pk_bf16_f32 v250, v244, v245
  v_cvt_pk_bf16_f32 v251, v246, v247
  buffer_store_dwordx4 v[248:251], v2, s[12:15], s59 offen offset:3072 sc1
  s_waitcnt vmcnt(0)
  s_mov_b64 exec, 1
  v_mov_b32 v3, s1
  buffer_store_dword v3, off, s[12:15], s51  sc1
  s_mov_b64 exec, -1
  s_add_u32 m0, s19, 8192
  s_nop 0
  buffer_load_dwordx4 v76, s[32:35], s16 offen lds
  buffer_load_dwordx4 v77, s[32:35], s16 offen offset:1024 lds
  s_add_u32 s16, s16, 14336
  s_add_u32 m0, s19, 10240
  s_nop 0
  buffer_load_dwordx4 v76, s[32:35], s16 offen lds
  buffer_load_dwordx4 v77, s[32:35], s16 offen offset:1024 lds
  s_add_u32 s16, s16, 14336
  s_cmp_eq_u32 s16, s18
  s_cselect_b32 s16, s17, s16
  s_add_u32 m0, s19, 0
  s_nop 0
  buffer_load_dwordx4 v76, s[32:35], s16 offen lds
  buffer_load_dwordx4 v77, s[32:35], s16 offen offset:1024 lds
  s_add_u32 s16, s16, 14336
  s_add_u32 m0, s19, 2048
  s_nop 0
  buffer_load_dwordx4 v76, s[32:35], s16 offen lds
  buffer_load_dwordx4 v77, s[32:35], s16 offen offset:1024 lds
  s_add_u32 s16, s16, 14336
  s_add_u32 m0, s19, 4096
  s_nop 0
  buffer_load_dwordx4 v76, s[32:35], s16 offen lds
  buffer_load_dwordx4 v77, s[32:35], s16 offen offset:1024 lds
  s_add_u32 s16, s16, 14336
  s_waitcnt lgkmcnt(0)
  s_add_u32 m0, s19, 6144
  s_nop 0
  buffer_load_dwordx4 v76, s[32:35], s16 offen lds
  buffer_load_dwordx4 v77, s[32:35], s16 offen offset:1024 lds
  s_add_u32 s16, s16, 14336
  s_cmp_eq_u32 s16, s18
  s_cselect_b32 s16, s17, s16
  s_waitcnt vmcnt(10)
  ds_read_b64_tr_b16 a[48:49], v78 offset:8192
  ds_read_b64_tr_b16 a[50:51], v78 offset:8704
  ds_read_b64_tr_b16 a[52:53], v79 offset:8192
  ds_read_b64_tr_b16 a[54:55], v79 offset:8704
  s_waitcnt vmcnt(8)
  ds_read_b64_tr_b16 a[56:57], v78 offset:10240
  ds_read_b64_tr_b16 a[58:59], v78 offset:10752
  ds_read_b64_tr_b16 a[60:61], v79 offset:10240
  ds_read_b64_tr_b16 a[62:63], v79 offset:10752
  s_waitcnt vmcnt(6)
  ds_read_b64_tr_b16 a[64:65], v78 offset:0
  ds_read_b64_tr_b16 a[66:67], v78 offset:512
  ds_read_b64_tr_b16 a[68:69], v79 offset:0
  ds_read_b64_tr_b16 a[70:71], v79 offset:512
  s_waitcnt vmcnt(4)
  ds_read_b64_tr_b16 a[72:73], v78 offset:2048
  ds_read_b64_tr_b16 a[74:75], v78 offset:2560
  ds_read_b64_tr_b16 a[76:77], v79 offset:2048
  ds_read_b64_tr_b16 a[78:79], v79 offset:2560
  s_waitcnt vmcnt(2)
  ds_read_b64_tr_b16 a[80:81], v78 offset:4096
  ds_read_b64_tr_b16 a[82:83], v78 offset:4608
  ds_read_b64_tr_b16 a[84:85], v79 offset:4096
  ds_read_b64_tr_b16 a[86:87], v79 offset:4608
  s_waitcnt vmcnt(0)
  ds_read_b64_tr_b16 a[88:89], v78 offset:6144
  ds_read_b64_tr_b16 a[90:91], v78 offset:6656
  ds_read_b64_tr_b16 a[92:93], v79 offset:6144
  ds_read_b64_tr_b16 a[94:95], v79 offset:6656
  s_mul_i32 s54, s40, 28672
  s_add_u32 s54, s54, 8388608
  s_mul_i32 s53, s43, 229376
  s_add_u32 s53, s53, s54
  s_add_u32 s54, s53, 28672
  s_lshl_b32 s52, s0, 12
  s_add_u32 s52, s52, s53
  s_and_b32 s48, s100, 1
  s_mul_i32 s48, s48, 114688
  v_add_u32 v6, s48, v2
  s_xor_b32 s48, s48, 114688
  v_add_u32 v15, s48, v2
  s_lshl_b32 s55, s43, 5
  s_mul_i32 s48, s40, 7
  s_add_u32 s55, s55, s48
  s_lshl_b32 s55, s55, 6
  s_add_u32 s55, s55, 524288
  v_lshlrev_b32 v128, 16, v16
  v_and_b32 v129, 0xffff0000, v16
  v_lshlrev_b32 v130, 16, v17
  v_and_b32 v131, 0xffff0000, v17
  v_lshlrev_b32 v132, 16, v18
  v_and_b32 v133, 0xffff0000, v18
  v_lshlrev_b32 v134, 16, v19
  v_and_b32 v135, 0xffff0000, v19
  v_lshlrev_b32 v136, 16, v20
  v_and_b32 v137, 0xffff0000, v20
  v_lshlrev_b32 v138, 16, v21
  v_and_b32 v139, 0xffff0000, v21
  v_lshlrev_b32 v140, 16, v22
  v_and_b32 v141, 0xffff0000, v22
  v_lshlrev_b32 v142, 16, v23
  v_and_b32 v143, 0xffff0000, v23
  v_min_u32 v4, 6, v1
  v_lshlrev_b32 v4, 6, v4
  s_waitcnt lgkmcnt(0)
  s_barrier
  s_mov_b32 s48, 262144
L_poll_p4:
  buffer_load_dword v5, v4, s[12:15], s55 offen sc1
  s_sub_u32 s48, s48, 1
  s_waitcnt vmcnt(0)
  v_cmp_eq_u32 vcc, s1, v5
  s_cbranch_scc1 L_pollx_p4
  s_andn2_b32 s49, 0x7f, vcc_lo
  s_cbranch_scc1 L_poll_p4
L_pollx_p4:
  buffer_load_dwordx4 v[192:195], v6, s[12:15], s52 offen offset:0 sc1
  buffer_load_dwordx4 v[196:199], v15, s[12:15], s52 offen offset:0 sc1
  buffer_load_dwordx4 v[200:203], v6, s[12:15], s52 offen offset:1024 sc1
  buffer_load_dwordx4 v[204:207], v15, s[12:15], s52 offen offset:1024 sc1
  buffer_load_dwordx4 v[208:211], v6, s[12:15], s52 offen offset:2048 sc1
  buffer_load_dwordx4 v[212:215], v15, s[12:15], s52 offen offset:2048 sc1
  buffer_load_dwordx4 v[216:219], v6, s[12:15], s52 offen offset:3072 sc1
  buffer_load_dwordx4 v[220:223], v15, s[12:15], s52 offen offset:3072 sc1
  s_add_u32 s52, s52, 4096
  s_cmp_eq_u32 s52, s54
  s_cselect_b32 s52, s53, s52
  buffer_load_dwordx4 v[224:227], v6, s[12:15], s52 offen offset:0 sc1
  buffer_load_dwordx4 v[228:231], v15, s[12:15], s52 offen offset:0 sc1
  buffer_load_dwordx4 v[232:235], v6, s[12:15], s52 offen offset:1024 sc1
  buffer_load_dwordx4 v[236:239], v15, s[12:15], s52 offen offset:1024 sc1
  buffer_load_dwordx4 v[240:243], v6, s[12:15], s52 offen offset:2048 sc1
  buffer_load_dwordx4 v[244:247], v15, s[12:15], s52 offen offset:2048 sc1
  buffer_load_dwordx4 v[248:251], v6, s[12:15], s52 offen offset:3072 sc1
  buffer_load_dwordx4 v[252:255], v15, s[12:15], s52 offen offset:3072 sc1
  s_add_u32 s52, s52, 4096
  s_cmp_eq_u32 s52, s54
  s_cselect_b32 s52, s53, s52
  s_waitcnt vmcnt(15)
  v_mfma_f32_32x32x16_bf16 v[128:143], a[96:99], v[192:195], v[128:143]
  v_mfma_f32_32x32x16_bf16 v[144:159], a[100:103], v[192:195], 0
  buffer_load_dwordx4 v[24:27], v6, s[12:15], s52 offen offset:0 sc1
  s_waitcnt vmcnt(15)
  v_mfma_f32_32x32x16_bf16 v[160:175], a[96:99], v[196:199], 0
  v_mfma_f32_32x32x16_bf16 v[176:191], a[100:103], v[196:199], 0
  buffer_load_dwordx4 v[28:31], v15, s[12:15], s52 offen offset:0 sc1
  s_waitcnt vmcnt(15)
  v_mfma_f32_32x32x16_bf16 v[128:143], a[104:107], v[200:203], v[128:143]
  v_mfma_f32_32x32x16_bf16 v[144:159], a[108:111], v[200:203], v[144:159]
  buffer_load_dwordx4 v[32:35], v6, s[12:15], s52 offen offset:1024 sc1
  s_waitcnt vmcnt(15)
  v_mfma_f32_32x32x16_bf16 v[160:175], a[104:107], v[204:207], v[160:175]
  v_mfma_f32_32x32x16_bf16 v[176:191], a[108:111], v[204:207], v[176:191]
  buffer_load_dwordx4 v[36:39], v15, s[12:15], s52 offen offset:1024 sc1
  s_waitcnt vmcnt(15)
  v_mfma_f32_32x32x16_bf16 v[128:143], a[112:115], v[208:211], v[128:143]
  v_mfma_f32_32x32x16_bf16 v[144:159], a[116:119], v[208:211], v[144:159]
  buffer_load_dwordx4 v[40:43], v6, s[12:15], s52 offen offset:2048 sc1
  s_waitcnt vmcnt(15)
  v_mfma_f32_32x32x16_bf16 v[160:175], a[112:115], v[212:215], v[160:175]
  v_mfma_f32_32x32x16_bf16 v[176:191], a[116:119], v[212:215], v[176:191]
  buffer_load_dwordx4 v[44:47], v15, s[12:15], s52 offen offset:2048 sc1
  s_waitcnt vmcnt(15)
  v_mfma_f32_32x32x16_bf16 v[128:143], a[120:123], v[216:219], v[128:143]
  v_mfma_f32_32x32x16_bf16 v[144:159], a[124:127], v[216:219], v[144:159]
  buffer_load_dwordx4 v[48:51], v6, s[12:15], s52 offen offset:3072 sc1
  s_waitcnt vmcnt(15)
  v_mfma_f32_32x32x16_bf16 v[160:175], a[120:123], v[220:223], v[160:175]
  v_mfma_f32_32x32x16_bf16 v[176:191], a[124:127], v[220:223], v[176:191]
  buffer_load_dwordx4 v[52:55], v15, s[12:15], s52 offen offset:3072 sc1
  s_add_u32 s52, s52, 4096
  s_cmp_eq_u32 s52, s54
  s_cselect_b32 s52, s53, s52
  s_waitcnt vmcnt(15)
  v_mfma_f32_32x32x16_bf16 v[128:143], a[128:131], v[224:227], v[128:143]
  v_mfma_f32_32x32x16_bf16 v[144:159], a[132:135], v[224:227], v[144:159]
  buffer_load_dwordx4 v[56:59], v6, s[12:15], s52 offen offset:0 sc1
  s_waitcnt vmcnt(15)
  v_mfma_f32_32x32x16_bf16 v[160:175], a[128:131], v[228:231], v[160:175]
  v_mfma_f32_32x32x16_bf16 v[176:191], a[132:135], v[228:231], v[176:191]
  buffer_load_dwordx4 v[60:63], v15, s[12:15], s52 offen offset:0 sc1
  s_waitcnt vmcnt(15)
  v_mfma_f32_32x32x16_bf16 v[128:143], a[136:139], v[232:235], v[128:143]
  v_mfma_f32_32x32x16_bf16 v[144:159], a[140:143], v[232:235], v[144:159]
  buffer_load_dwordx4 v[64:67], v6, s[12:15], s52 offen offset:1024 sc1
  s_waitcnt vmcnt(15)
  v_mfma_f32_32x32x16_bf16 v[160:175], a[136:139], v[236:239], v[160:175]
  v_mfma_f32_32x32x16_bf16 v[176:191], a[140:143], v[236:239], v[176:191]
  buffer_load_dwordx4 v[68:71], v15, s[12:15], s52 offen offset:1024 sc1
  s_waitcnt vmcnt(15)
  v_mfma_f32_32x32x16_bf16 v[128:143], a[144:147], v[240:243], v[128:143]
  v_mfma_f32_32x32x16_bf16 v[144:159], a[148:151], v[240:243], v[144:159]
  buffer_load_dwordx4 v[80:83], v6, s[12:15], s52 offen offset:2048 sc1
  s_waitcnt vmcnt(15)
  v_mfma_f32_32x32x16_bf16 v[160:175], a[144:147], v[244:247], v[160:175]
  v_mfma_f32_32x32x16_bf16 v[176:191], a[148:151], v[244:247], v[176:191]
  buffer_load_dwordx4 v[84:87], v15, s[12:15], s52 offen offset:2048 sc1
  s_waitcnt vmcnt(15)
  v_mfma_f32_32x32x16_bf16 v[128:143], a[152:155], v[248:251], v[128:143]
  v_mfma_f32_32x32x16_bf16 v[144:159], a[156:159], v[248:251], v[144:159]
  buffer_load_dwordx4 v[88:91], v6, s[12:15], s52 offen offset:3072 sc1
  s_waitcnt vmcnt(15)
  v_mfma_f32_32x32x16_bf16 v[160:175], a[152:155], v[252:255], v[160:175]
  v_mfma_f32_32x32x16_bf16 v[176:191], a[156:159], v[252:255], v[176:191]
  buffer_load_dwordx4 v[92:95], v15, s[12:15], s52 offen offset:3072 sc1
  s_add_u32 s52, s52, 4096
  s_cmp_eq_u32 s52, s54
  s_cselect_b32 s52, s53, s52
  s_waitcnt vmcnt(15)
  v_mfma_f32_32x32x16_bf16 v[128:143], a[160:163], v[24:27], v[128:143]
  v_mfma_f32_32x32x16_bf16 v[144:159], a[164:167], v[24:27], v[144:159]
  buffer_load_dwordx4 v[96:99], v6, s[12:15], s52 offen offset:0 sc1
  s_waitcnt vmcnt(15)
  v_mfma_f32_32x32x16_bf16 v[160:175], a[160:163], v[28:31], v[160:175]
  v_mfma_f32_32x32x16_bf16 v[176:191], a[164:167], v[28:31], v[176:191]
  buffer_load_dwordx4 v[100:103], v15, s[12:15], s52 offen offset:0 sc1
  s_waitcnt vmcnt(15)
  v_mfma_f32_32x32x16_bf16 v[128:143], a[168:171], v[32:35], v[128:143]
  v_mfma_f32_32x32x16_bf16 v[144:159], a[172:175], v[32:35], v[144:159]
  buffer_load_dwordx4 v[104:107], v6, s[12:15], s52 offen offset:1024 sc1
  s_waitcnt vmcnt(15)
  v_mfma_f32_32x32x16_bf16 v[160:175], a[168:171], v[36:39], v[160:175]
  v_mfma_f32_32x32x16_bf16 v[176:191], a[172:175], v[36:39], v[176:191]
  buffer_load_dwordx4 v[108:111], v15, s[12:15], s52 offen offset:1024 sc1
  s_waitcnt vmcnt(15)
  v_mfma_f32_32x32x16_bf16 v[128:143], a[176:179], v[40:43], v[128:143]
  v_mfma_f32_32x32x16_bf16 v[144:159], a[180:183], v[40:43], v[144:159]
  buffer_load_dwordx4 v[112:115], v6, s[12:15], s52 offen offset:2048 sc1
  s_waitcnt vmcnt(15)
  v_mfma_f32_32x32x16_bf16 v[160:175], a[176:179], v[44:47], v[160:175]
  v_mfma_f32_32x32x16_bf16 v[176:191], a[180:183], v[44:47], v[176:191]
  buffer_load_dwordx4 v[116:119], v15, s[12:15], s52 offen offset:2048 sc1
  s_waitcnt vmcnt(15)
  v_mfma_f32_32x32x16_bf16 v[128:143], a[184:187], v[48:51], v[128:143]
  v_mfma_f32_32x32x16_bf16 v[144:159], a[188:191], v[48:51], v[144:159]
  buffer_load_dwordx4 v[120:123], v6, s[12:15], s52 offen offset:3072 sc1
  s_waitcnt vmcnt(15)
  v_mfma_f32_32x32x16_bf16 v[160:175], a[184:187], v[52:55], v[160:175]
  v_mfma_f32_32x32x16_bf16 v[176:191], a[188:191], v[52:55], v[176:191]
  buffer_load_dwordx4 v[124:127], v15, s[12:15], s52 offen offset:3072 sc1
  s_add_u32 s52, s52, 4096
  s_cmp_eq_u32 s52, s54
  s_cselect_b32 s52, s53, s52
  s_waitcnt vmcnt(15)
  v_mfma_f32_32x32x16_bf16 v[128:143], a[192:195], v[56:59], v[128:143]
  v_mfma_f32_32x32x16_bf16 v[144:159], a[196:199], v[56:59], v[144:159]
  buffer_load_dwordx4 a[0:3], v6, s[12:15], s52 offen offset:0 sc1
  s_waitcnt vmcnt(15)
  v_mfma_f32_32x32x16_bf16 v[160:175], a[192:195], v[60:63], v[160:175]
  v_mfma_f32_32x32x16_bf16 v[176:191], a[196:199], v[60:63], v[176:191]
  buffer_load_dwordx4 a[4:7], v15, s[12:15], s52 offen offset:0 sc1
  s_waitcnt vmcnt(15)
  v_mfma_f32_32x32x16_bf16 v[128:143], a[200:203], v[64:67], v[128:143]
  v_mfma_f32_32x32x16_bf16 v[144:159], a[204:207], v[64:67], v[144:159]
  buffer_load_dwordx4 a[8:11], v6, s[12:15], s52 offen offset:1024 sc1
  s_waitcnt vmcnt(15)
  v_mfma_f32_32x32x16_bf16 v[160:175], a[200:203], v[68:71], v[160:175]
  v_mfma_f32_32x32x16_bf16 v[176:191], a[204:207], v[68:71], v[176:191]
  buffer_load_dwordx4 a[12:15], v15, s[12:15], s52 offen offset:1024 sc1
  s_waitcnt vmcnt(15)
  v_mfma_f32_32x32x16_bf16 v[128:143], a[208:211], v[80:83], v[128:143]
  v_mfma_f32_32x32x16_bf16 v[144:159], a[212:215], v[80:83], v[144:159]
  buffer_load_dwordx4 a[16:19], v6, s[12:15], s52 offen offset:2048 sc1
  s_waitcnt vmcnt(15)
  v_mfma_f32_32x32x16_bf16 v[160:175], a[208:211], v[84:87], v[160:175]
  v_mfma_f32_32x32x16_bf16 v[176:191], a[212:215], v[84:87], v[176:191]
  buffer_load_dwordx4 a[20:23], v15, s[12:15], s52 offen offset:2048 sc1
  s_waitcnt vmcnt(15)
  v_mfma_f32_32x32x16_bf16 v[128:143], a[216:219], v[88:91], v[128:143]
  v_mfma_f32_32x32x16_bf16 v[144:159], a[220:223], v[88:91], v[144:159]
  buffer_load_dwordx4 a[24:27], v6, s[12:15], s52 offen offset:3072 sc1
  s_waitcnt vmcnt(15)
  v_mfma_f32_32x32x16_bf16 v[160:175], a[216:219], v[92:95], v[160:175]
  v_mfma_f32_32x32x16_bf16 v[176:191], a[220:223], v[92:95], v[176:191]
  buffer_load_dwordx4 a[28:31], v15, s[12:15], s52 offen offset:3072 sc1
  s_add_u32 s52, s52, 4096
  s_cmp_eq_u32 s52, s54
  s_cselect_b32 s52, s53, s52
  s_waitcnt vmcnt(15)
  v_mfma_f32_32x32x16_bf16 v[128:143], a[224:227], v[96:99], v[128:143]
  v_mfma_f32_32x32x16_bf16 v[144:159], a[228:231], v[96:99], v[144:159]
  buffer_load_dwordx4 v[192:195], v6, s[12:15], s52 offen offset:0 sc1
  s_waitcnt vmcnt(15)
  v_mfma_f32_32x32x16_bf16 v[160:175], a[224:227], v[100:103], v[160:175]
  v_mfma_f32_32x32x16_bf16 v[176:191], a[228:231], v[100:103], v[176:191]
  buffer_load_dwordx4 v[196:199], v15, s[12:15], s52 offen offset:0 sc1
  s_waitcnt vmcnt(15)
  v_mfma_f32_32x32x16_bf16 v[128:143], a[232:235], v[104:107], v[128:143]
  v_mfma_f32_32x32x16_bf16 v[144:159], a[236:239], v[104:107], v[144:159]
  buffer_load_dwordx4 v[200:203], v6, s[12:15], s52 offen offset:1024 sc1
  s_waitcnt vmcnt(15)
  v_mfma_f32_32x32x16_bf16 v[160:175], a[232:235], v[108:111], v[160:175]
  v_mfma_f32_32x32x16_bf16 v[176:191], a[236:239], v[108:111], v[176:191]
  buffer_load_dwordx4 v[204:207], v15, s[12:15], s52 offen offset:1024 sc1
  s_waitcnt vmcnt(15)
  v_mfma_f32_32x32x16_bf16 v[128:143], a[240:243], v[112:115], v[128:143]
  v_mfma_f32_32x32x16_bf16 v[144:159], a[244:247], v[112:115], v[144:159]
  buffer_load_dwordx4 v[208:211], v6, s[12:15], s52 offen offset:2048 sc1
  s_waitcnt vmcnt(15)
  v_mfma_f32_32x32x16_bf16 v[160:175], a[240:243], v[116:119], v[160:175]
  v_mfma_f32_32x32x16_bf16 v[176:191], a[244:247], v[116:119], v[176:191]
  buffer_load_dwordx4 v[212:215], v15, s[12:15], s52 offen offset:2048 sc1
  s_waitcnt vmcnt(15)
  v_mfma_f32_32x32x16_bf16 v[128:143], a[248:251], v[120:123], v[128:143]
  v_mfma_f32_32x32x16_bf16 v[144:159], a[252:255], v[120:123], v[144:159]
  buffer_load_dwordx4 v[216:219], v6, s[12:15], s52 offen offset:3072 sc1
  s_waitcnt vmcnt(15)
  v_mfma_f32_32x32x16_bf16 v[160:175], a[248:251], v[124:127], v[160:175]
  v_mfma_f32_32x32x16_bf16 v[176:191], a[252:255], v[124:127], v[176:191]
  buffer_load_dwordx4 v[220:223], v15, s[12:15], s52 offen offset:3072 sc1
  s_add_u32 s52, s52, 4096
  s_cmp_eq_u32 s52, s54
  s_cselect_b32 s52, s53, s52
  s_waitcnt vmcnt(15)
  v_mfma_f32_32x32x16_bf16 v[128:143], a[32:35], a[0:3], v[128:143]
  v_mfma_f32_32x32x16_bf16 v[144:159], a[36:39], a[0:3], v[144:159]
  s_waitcnt vmcnt(14)
  v_mfma_f32_32x32x16_bf16 v[160:175], a[32:35], a[4:7], v[160:175]
  v_mfma_f32_32x32x16_bf16 v[176:191], a[36:39], a[4:7], v[176:191]
  s_waitcnt vmcnt(13)
  v_mfma_f32_32x32x16_bf16 v[128:143], a[40:43], a[8:11], v[128:143]
  v_mfma_f32_32x32x16_bf16 v[144:159], a[44:47], a[8:11], v[144:159]
  s_waitcnt vmcnt(12)
  v_mfma_f32_32x32x16_bf16 v[160:175], a[40:43], a[12:15], v[160:175]
  v_mfma_f32_32x32x16_bf16 v[176:191], a[44:47], a[12:15], v[176:191]
  s_waitcnt vmcnt(11)
  v_mfma_f32_32x32x16_bf16 v[128:143], a[48:51], a[16:19], v[128:143]
  v_mfma_f32_32x32x16_bf16 v[144:159], a[52:55], a[16:19], v[144:159]
  s_waitcnt vmcnt(10)
  v_mfma_f32_32x32x16_bf16 v[160:175], a[48:51], a[20:23], v[160:175]
  v_mfma_f32_32x32x16_bf16 v[176:191], a[52:55], a[20:23], v[176:191]
  s_waitcnt vmcnt(9)
  v_mfma_f32_32x32x16_bf16 v[128:143], a[56:59], a[24:27], v[128:143]
  v_mfma_f32_32x32x16_bf16 v[144:159], a[60:63], a[24:27], v[144:159]
  s_waitcnt vmcnt(8)
  v_mfma_f32_32x32x16_bf16 v[160:175], a[56:59], a[28:31], v[160:175]
  v_mfma_f32_32x32x16_bf16 v[176:191], a[60:63], a[28:31], v[176:191]
  s_waitcnt vmcnt(7)
  v_mfma_f32_32x32x16_bf16 v[128:143], a[64:67], v[192:195], v[128:143]
  v_mfma_f32_32x32x16_bf16 v[144:159], a[68:71], v[192:195], v[144:159]
  s_waitcnt vmcnt(6)
  v_mfma_f32_32x32x16_bf16 v[160:175], a[64:67], v[196:199], v[160:175]
  v_mfma_f32_32x32x16_bf16 v[176:191], a[68:71], v[196:199], v[176:191]
  s_waitcnt vmcnt(5)
  v_mfma_f32_32x32x16_bf16 v[128:143], a[72:75], v[200:203], v[128:143]
  v_mfma_f32_32x32x16_bf16 v[144:159], a[76:79], v[200:203], v[144:159]
  s_waitcnt vmcnt(4)
  v_mfma_f32_32x32x16_bf16 v[160:175], a[72:75], v[204:207], v[160:175]
  v_mfma_f32_32x32x16_bf16 v[176:191], a[76:79], v[204:207], v[176:191]
  s_waitcnt vmcnt(3)
  v_mfma_f32_32x32x16_bf16 v[128:143], a[80:83], v[208:211], v[128:143]
  v_mfma_f32_32x32x16_bf16 v[144:159], a[84:87], v[208:211], v[144:159]
  s_waitcnt vmcnt(2)
  v_mfma_f32_32x32x16_bf16 v[160:175], a[80:83], v[212:215], v[160:175]
  v_mfma_f32_32x32x16_bf16 v[176:191], a[84:87], v[212:215], v[176:191]
  s_waitcnt vmcnt(0)
  v_mfma_f32_32x32x16_bf16 v[176:191], a[92:95], v[220:223], v[176:191]
  v_mfma_f32_32x32x16_bf16 v[160:175], a[88:91], v[220:223], v[160:175]
  v_mfma_f32_32x32x16_bf16 v[144:159], a[92:95], v[216:219], v[144:159]
  v_mfma_f32_32x32x16_bf16 v[128:143], a[88:91], v[216:219], v[128:143]
  s_nop 8
  ds_write_b128 v75, v[176:179] offset:0
  ds_write_b128 v75, v[180:183] offset:1024
  ds_write_b128 v75, v[184:187] offset:2048
  ds_write_b128 v75, v[188:191] offset:3072
  ds_write_b128 v74, v[160:163] offset:0
  ds_write_b128 v74, v[164:167] offset:1024
  ds_write_b128 v74, v[168:171] offset:2048
  ds_write_b128 v74, v[172:175] offset:3072
  ds_write_b128 v73, v[144:147] offset:0
  ds_write_b128 v73, v[148:151] offset:1024
  ds_write_b128 v73, v[152:155] offset:2048
  ds_write_b128 v73, v[156:159] offset:3072
  s_waitcnt lgkmcnt(0)
  s_barrier
  ds_read_b128 v[144:147], v72 offset:0
  ds_read_b128 v[148:151], v72 offset:1024
  ds_read_b128 v[152:155], v72 offset:2048
  ds_read_b128 v[156:159], v72 offset:3072
  ds_read_b128 v[160:163], v72 offset:4096
  ds_read_b128 v[164:167], v72 offset:5120
  ds_read_b128 v[168:171], v72 offset:6144
  ds_read_b128 v[172:175], v72 offset:7168
  ds_read_b128 v[176:179], v72 offset:8192
  ds_read_b128 v[180:183], v72 offset:9216
  ds_read_b128 v[184:187], v72 offset:10240
  ds_read_b128 v[188:191], v72 offset:11264
  s_waitcnt lgkmcnt(11)
  v_pk_add_f32 v[128:129], v[128:129], v[144:145]
  v_pk_add_f32 v[130:131], v[130:131], v[146:147]
  s_waitcnt lgkmcnt(10)
  v_pk_add_f32 v[132:133], v[132:133], v[148:149]
  v_pk_add_f32 v[134:135], v[134:135], v[150:151]
  s_waitcnt lgkmcnt(9)
  v_pk_add_f32 v[136:137], v[136:137], v[152:153]
  v_pk_add_f32 v[138:139], v[138:139], v[154:155]
  s_waitcnt lgkmcnt(8)
  v_pk_add_f32 v[140:141], v[140:141], v[156:157]
  v_pk_add_f32 v[142:143], v[142:143], v[158:159]
  s_waitcnt lgkmcnt(7)
  v_pk_add_f32 v[128:129], v[128:129], v[160:161]
  v_pk_add_f32 v[130:131], v[130:131], v[162:163]
  s_waitcnt lgkmcnt(6)
  v_pk_add_f32 v[132:133], v[132:133], v[164:165]
  v_pk_add_f32 v[134:135], v[134:135], v[166:167]
  s_waitcnt lgkmcnt(5)
  v_pk_add_f32 v[136:137], v[136:137], v[168:169]
  v_pk_add_f32 v[138:139], v[138:139], v[170:171]
  s_waitcnt lgkmcnt(4)
  v_pk_add_f32 v[140:141], v[140:141], v[172:173]
  v_pk_add_f32 v[142:143], v[142:143], v[174:175]
  s_waitcnt lgkmcnt(3)
  v_pk_add_f32 v[128:129], v[128:129], v[176:177]
  v_pk_add_f32 v[130:131], v[130:131], v[178:179]
  s_waitcnt lgkmcnt(2)
  v_pk_add_f32 v[132:133], v[132:133], v[180:181]
  v_pk_add_f32 v[134:135], v[134:135], v[182:183]
  s_waitcnt lgkmcnt(1)
  v_pk_add_f32 v[136:137], v[136:137], v[184:185]
  v_pk_add_f32 v[138:139], v[138:139], v[186:187]
  s_waitcnt lgkmcnt(0)
  v_pk_add_f32 v[140:141], v[140:141], v[188:189]
  v_pk_add_f32 v[142:143], v[142:143], v[190:191]
  v_cvt_pk_bf16_f32 v16, v128, v129
  v_cvt_pk_bf16_f32 v17, v130, v131
  v_cvt_pk_bf16_f32 v18, v132, v133
  v_cvt_pk_bf16_f32 v19, v134, v135
  v_cvt_pk_bf16_f32 v20, v136, v137
  v_cvt_pk_bf16_f32 v21, v138, v139
  v_cvt_pk_bf16_f32 v22, v140, v141
  v_cvt_pk_bf16_f32 v23, v142, v143
  buffer_store_dwordx4 v[16:19], v14, s[36:39], s101 offen
  buffer_store_dwordx4 v[20:23], v14, s[36:39], s101 offen offset:32
  s_or_b32 s48, s2, s40
  s_cbranch_scc1 L_fin
  s_mov_b64 exec, 1
  v_mov_b32 v3, s1
  buffer_store_dword v3, off, s[12:15], 0
L_fin:
L_end:
  s_endpgm
L_fin0:
  s_and_b32 s48, s47, 3
  s_and_b32 s49, s3, 1
  s_lshl_b32 s49, s49, 2
  s_add_u32 s48, s48, s49
  s_min_u32 s48, s48, 6
  s_lshr_b32 s46, s3, 1
  s_mul_i32 s46, s46, 7
  s_add_u32 s46, s46, s48
  v_lshrrev_b32 v4, 3, v1
  v_mul_u32_u24 v122, 3584, v4
  v_bfe_u32 v4, v1, 4, 1
  v_lshlrev_b32 v4, 1, v4
  v_and_b32 v5, 7, v1
  v_xor_b32 v4, v4, v5
  v_xor_b32 v5, 4, v4
  v_lshl_add_u32 v124, v5, 4, v122
  v_lshl_add_u32 v122, v4, 4, v122
  v_add_u32 v125, 27648, v124
  v_add_u32 v123, 27648, v122
  s_mul_i32 s53, s40, 57344
  s_lshl_b32 s54, s46, 7
  s_add_u32 s53, s53, s54
  s_add_u32 s54, s53, 1605632
  s_mul_i32 s50, s0, 229376
  s_add_u32 s50, s50, s53
  s_mov_b32 s51, s50
  s_mul_i32 s19, s40, 12288
  s_add_u32 s19, s19, 114688
  s_waitcnt vmcnt(0) lgkmcnt(0)
  s_barrier
  s_add_u32 m0, s52, 57344
  s_nop 0
  buffer_load_dwordx4 v124, s[28:31], s50 offen lds
  s_branch L_ov6
  .p2align 12
L_pg6:
  s_branch L_bk2
L_ov6:
  s_add_u32 m0, s52, 57344
  s_nop 0
  buffer_load_dwordx4 v125, s[28:31], s50 offen offset:1024 lds
  s_add_u32 s50, s50, 229376
  s_cmp_eq_u32 s50, s54
  s_cselect_b32 s50, s53, s50
  s_add_u32 m0, s52, 65536
  s_nop 0
  buffer_load_dwordx4 v124, s[28:31], s50 offen lds
  s_add_u32 m0, s52, 65536
  s_nop 0
  buffer_load_dwordx4 v125, s[28:31], s50 offen offset:1024 lds
  s_add_u32 s50, s50, 229376
  s_cmp_eq_u32 s50, s54
  s_cselect_b32 s50, s53, s50
  s_add_u32 m0, s52, 73728
  s_nop 0
  buffer_load_dwordx4 v124, s[28:31], s50 offen lds
  s_add_u32 m0, s52, 73728
  s_nop 0
  buffer_load_dwordx4 v125, s[28:31], s50 offen offset:1024 lds
  s_add_u32 s50, s50, 229376
  s_cmp_eq_u32 s50, s54
  s_cselect_b32 s50, s53, s50
  s_add_u32 m0, s52, 81920
  s_nop 0
  buffer_load_dwordx4 v124, s[28:31], s50 offen lds
  s_add_u32 m0, s52, 81920
  s_nop 0
  buffer_load_dwordx4 v125, s[28:31], s50 offen offset:1024 lds
  s_add_u32 s50, s50, 229376
  s_cmp_eq_u32 s50, s54
  s_cselect_b32 s50, s53, s50
  s_add_u32 m0, s52, 90112
  s_nop 0
  buffer_load_dwordx4 v124, s[28:31], s50 offen lds
  s_add_u32 m0, s52, 90112
  s_nop 0
  buffer_load_dwordx4 v125, s[28:31], s50 offen offset:1024 lds
  s_add_u32 s50, s50, 229376
  s_cmp_eq_u32 s50, s54
  s_cselect_b32 s50, s53, s50
  s_add_u32 m0, s52, 98304
  s_nop 0
  buffer_load_dwordx4 v124, s[28:31], s50 offen lds
  s_add_u32 m0, s52, 98304
  s_nop 0
  buffer_load_dwordx4 v125, s[28:31], s50 offen offset:1024 lds
  s_add_u32 s50, s50, 229376
  s_cmp_eq_u32 s50, s54
  s_cselect_b32 s50, s53, s50
  s_add_u32 m0, s52, 106496
  s_nop 0
  buffer_load_dwordx4 v124, s[28:31], s50 offen lds
  s_add_u32 m0, s52, 106496
  s_nop 0
  buffer_load_dwordx4 v125, s[28:31], s50 offen offset:1024 lds
  s_add_u32 s50, s50, 229376
  s_cmp_eq_u32 s50, s54
  s_cselect_b32 s50, s53, s50
  s_add_u32 m0, s52, 0
  s_nop 0
  buffer_load_dwordx4 v122, s[24:27], s51 offen lds
  s_add_u32 m0, s52, 0
  s_nop 0
  buffer_load_dwordx4 v123, s[24:27], s51 offen offset:1024 lds
  s_add_u32 s51, s51, 229376
  s_cmp_eq_u32 s51, s54
  s_cselect_b32 s51, s53, s51
  s_add_u32 m0, s52, 8192
  s_nop 0
  buffer_load_dwordx4 v122, s[24:27], s51 offen lds
  s_add_u32 m0, s52, 8192
  s_nop 0
  buffer_load_dwordx4 v123, s[24:27], s51 offen offset:1024 lds
  s_add_u32 s51, s51, 229376
  s_cmp_eq_u32 s51, s54
  s_cselect_b32 s51, s53, s51
  s_add_u32 m0, s52, 16384
  s_nop 0
  buffer_load_dwordx4 v122, s[24:27], s51 offen lds
  s_add_u32 m0, s52, 16384
  s_nop 0
  buffer_load_dwordx4 v123, s[24:27], s51 offen offset:1024 lds
  s_add_u32 s51, s51, 229376
  s_cmp_eq_u32 s51, s54
  s_cselect_b32 s51, s53, s51
  s_add_u32 m0, s52, 24576
  s_nop 0
  buffer_load_dwordx4 v122, s[24:27], s51 offen lds
  s_add_u32 m0, s52, 24576
  s_nop 0
  buffer_load_dwordx4 v123, s[24:27], s51 offen offset:1024 lds
  s_add_u32 s51, s51, 229376
  s_cmp_eq_u32 s51, s54
  s_cselect_b32 s51, s53, s51
  s_add_u32 m0, s52, 32768
  s_nop 0
  buffer_load_dwordx4 v122, s[24:27], s51 offen lds
  s_add_u32 m0, s52, 32768
  s_nop 0
  buffer_load_dwordx4 v123, s[24:27], s51 offen offset:1024 lds
  s_add_u32 s51, s51, 229376
  s_cmp_eq_u32 s51, s54
  s_cselect_b32 s51, s53, s51
  s_add_u32 m0, s52, 40960
  s_nop 0
  buffer_load_dwordx4 v122, s[24:27], s51 offen lds
  s_add_u32 m0, s52, 40960
  s_nop 0
  buffer_load_dwordx4 v123, s[24:27], s51 offen offset:1024 lds
  s_add_u32 s51, s51, 229376
  s_cmp_eq_u32 s51, s54
  s_cselect_b32 s51, s53, s51
  s_add_u32 m0, s52, 49152
  s_nop 0
  buffer_load_dwordx4 v122, s[24:27], s51 offen lds
  s_add_u32 m0, s52, 49152
  s_nop 0
  buffer_load_dwordx4 v123, s[24:27], s51 offen offset:1024 lds
  s_add_u32 s51, s51, 229376
  s_cmp_eq_u32 s51, s54
  s_cselect_b32 s51, s53, s51
  v_bfe_u32 v4, v1, 4, 1
  v_mul_u32_u24 v3, 57344, v4
  v_lshrrev_b32 v5, 5, v1
  v_lshl_add_u32 v3, v5, 10, v3
  v_bfe_u32 v5, v1, 2, 2
  v_lshl_add_u32 v3, v5, 7, v3
  v_and_b32 v5, 1, v1
  v_lshl_add_u32 v3, v5, 4, v3
  v_bfe_u32 v5, v1, 1, 1
  v_lshl_add_u32 v3, v5, 3, v3
  v_bfe_u32 v5, v1, 3, 2
  v_lshl_add_u32 v3, v5, 5, v3
  v_xor_b32 v24, 0, v3
  v_xor_b32 v25, 32, v3
  v_xor_b32 v26, 64, v3
  v_xor_b32 v27, 96, v3
  v_add_u32 v48, s52, v24
  v_add_u32 v49, s52, v25
  v_add_u32 v50, s52, v26
  v_add_u32 v51, s52, v27
  v_and_b32 v4, 15, v1
  v_bfe_u32 v5, v1, 4, 1
  v_sub_u32 v4, v4, v5
  v_mov_b32 v5, 1065369472
  v_mov_b32 v6, 0
  v_cmp_eq_u32 vcc, 0, v4
  s_nop 1
  v_cndmask_b32 v28, v6, v5
  v_cndmask_b32 v29, v6, v5
  v_cndmask_b32 v30, v6, v5
  v_cndmask_b32 v31, v6, v5
  v_cmp_eq_u32 vcc, 2, v4
  s_nop 1
  v_cndmask_b32 v32, v6, v5
  v_cndmask_b32 v33, v6, v5
  v_cndmask_b32 v34, v6, v5
  v_cndmask_b32 v35, v6, v5
  v_cmp_eq_u32 vcc, 4, v4
  s_nop 1
  v_cndmask_b32 v36, v6, v5
  v_cndmask_b32 v37, v6, v5
  v_cndmask_b32 v38, v6, v5
  v_cndmask_b32 v39, v6, v5
  v_cmp_eq_u32 vcc, 6, v4
  s_nop 1
  v_cndmask_b32 v40, v6, v5
  v_cndmask_b32 v41, v6, v5
  v_cndmask_b32 v42, v6, v5
  v_cndmask_b32 v43, v6, v5
  s_waitcnt vmcnt(0)
  ds_read_b64_tr_b16 v[128:129], v48 offset:0
  ds_read_b64_tr_b16 v[130:131], v48 offset:512
  ds_read_b64_tr_b16 v[132:133], v49 offset:0
  ds_read_b64_tr_b16 v[134:135], v49 offset:512
  ds_read_b64_tr_b16 v[136:137], v50 offset:0
  ds_read_b64_tr_b16 v[138:139], v50 offset:512
  ds_read_b64_tr_b16 v[140:141], v51 offset:0
  ds_read_b64_tr_b16 v[142:143], v51 offset:512
  ds_read_b64_tr_b16 v[144:145], v48 offset:8192
  ds_read_b64_tr_b16 v[146:147], v48 offset:8704
  ds_read_b64_tr_b16 v[148:149], v49 offset:8192
  ds_read_b64_tr_b16 v[150:151], v49 offset:8704
  ds_read_b64_tr_b16 v[152:153], v50 offset:8192
  ds_read_b64_tr_b16 v[154:155], v50 offset:8704
  ds_read_b64_tr_b16 v[156:157], v51 offset:8192
  ds_read_b64_tr_b16 v[158:159], v51 offset:8704
  s_waitcnt lgkmcnt(14)
  v_mfma_f32_16x16x32_bf16 v[44:47], v[28:31], v[128:131], 0
  s_waitcnt lgkmcnt(12)
  v_mfma_f32_16x16x32_bf16 v[44:47], v[32:35], v[132:135], v[44:47]
  s_waitcnt lgkmcnt(10)
  v_mfma_f32_16x16x32_bf16 v[44:47], v[36:39], v[136:139], v[44:47]
  s_waitcnt lgkmcnt(8)
  v_mfma_f32_16x16x32_bf16 v[44:47], v[40:43], v[140:143], v[44:47]
  ds_read_b64_tr_b16 v[160:161], v48 offset:16384
  ds_read_b64_tr_b16 v[162:163], v48 offset:16896
  ds_read_b64_tr_b16 v[164:165], v49 offset:16384
  ds_read_b64_tr_b16 v[166:167], v49 offset:16896
  ds_read_b64_tr_b16 v[168:169], v50 offset:16384
  ds_read_b64_tr_b16 v[170:171], v50 offset:16896
  ds_read_b64_tr_b16 v[172:173], v51 offset:16384
  ds_read_b64_tr_b16 v[174:175], v51 offset:16896
  s_waitcnt lgkmcnt(14)
  v_mfma_f32_16x16x32_bf16 v[44:47], v[28:31], v[144:147], v[44:47]
  s_waitcnt lgkmcnt(12)
  v_mfma_f32_16x16x32_bf16 v[44:47], v[32:35], v[148:151], v[44:47]
  s_waitcnt lgkmcnt(10)
  v_mfma_f32_16x16x32_bf16 v[44:47], v[36:39], v[152:155], v[44:47]
  s_waitcnt lgkmcnt(8)
  v_mfma_f32_16x16x32_bf16 v[44:47], v[40:43], v[156:159], v[44:47]
  ds_read_b64_tr_b16 v[176:177], v48 offset:24576
  ds_read_b64_tr_b16 v[178:179], v48 offset:25088
  ds_read_b64_tr_b16 v[180:181], v49 offset:24576
  ds_read_b64_tr_b16 v[182:183], v49 offset:25088
  ds_read_b64_tr_b16 v[184:185], v50 offset:24576
  ds_read_b64_tr_b16 v[186:187], v50 offset:25088
  ds_read_b64_tr_b16 v[188:189], v51 offset:24576
  ds_read_b64_tr_b16 v[190:191], v51 offset:25088
  s_waitcnt lgkmcnt(14)
  v_mfma_f32_16x16x32_bf16 v[44:47], v[28:31], v[160:163], v[44:47]
  s_waitcnt lgkmcnt(12)
  v_mfma_f32_16x16x32_bf16 v[44:47], v[32:35], v[164:167], v[44:47]
  s_waitcnt lgkmcnt(10)
  v_mfma_f32_16x16x32_bf16 v[44:47], v[36:39], v[168:171], v[44:47]
  s_waitcnt lgkmcnt(8)
  v_mfma_f32_16x16x32_bf16 v[44:47], v[40:43], v[172:175], v[44:47]
  ds_read_b64_tr_b16 v[128:129], v48 offset:32768
  ds_read_b64_tr_b16 v[130:131], v48 offset:33280
  ds_read_b64_tr_b16 v[132:133], v49 offset:32768
  ds_read_b64_tr_b16 v[134:135], v49 offset:33280
  ds_read_b64_tr_b16 v[136:137], v50 offset:32768
  ds_read_b64_tr_b16 v[138:139], v50 offset:33280
  ds_read_b64_tr_b16 v[140:141], v51 offset:32768
  ds_read_b64_tr_b16 v[142:143], v51 offset:33280
  s_waitcnt lgkmcnt(14)
  v_mfma_f32_16x16x32_bf16 v[44:47], v[28:31], v[176:179], v[44:47]
  s_waitcnt lgkmcnt(12)
  v_mfma_f32_16x16x32_bf16 v[44:47], v[32:35], v[180:183], v[44:47]
  s_waitcnt lgkmcnt(10)
  v_mfma_f32_16x16x32_bf16 v[44:47], v[36:39], v[184:187], v[44:47]
  s_waitcnt lgkmcnt(8)
  v_mfma_f32_16x16x32_bf16 v[44:47], v[40:43], v[188:191], v[44:47]
  ds_read_b64_tr_b16 v[144:145], v48 offset:40960
  ds_read_b64_tr_b16 v[146:147], v48 offset:41472
  ds_read_b64_tr_b16 v[148:149], v49 offset:40960
  ds_read_b64_tr_b16 v[150:151], v49 offset:41472
  ds_read_b64_tr_b16 v[152:153], v50 offset:40960
  ds_read_b64_tr_b16 v[154:155], v50 offset:41472
  ds_read_b64_tr_b16 v[156:157], v51 offset:40960
  ds_read_b64_tr_b16 v[158:159], v51 offset:41472
  s_waitcnt lgkmcnt(14)
  v_mfma_f32_16x16x32_bf16 v[44:47], v[28:31], v[128:131], v[44:47]
  s_waitcnt lgkmcnt(12)
  v_mfma_f32_16x16x32_bf16 v[44:47], v[32:35], v[132:135], v[44:47]
  s_waitcnt lgkmcnt(10)
  v_mfma_f32_16x16x32_bf16 v[44:47], v[36:39], v[136:139], v[44:47]
  s_waitcnt lgkmcnt(8)
  v_mfma_f32_16x16x32_bf16 v[44:47], v[40:43], v[140:143], v[44:47]
  ds_read_b64_tr_b16 v[160:161], v48 offset:49152
  ds_read_b64_tr_b16 v[162:163], v48 offset:49664
  ds_read_b64_tr_b16 v[164:165], v49 offset:49152
  ds_read_b64_tr_b16 v[166:167], v49 offset:49664
  ds_read_b64_tr_b16 v[168:169], v50 offset:49152
  ds_read_b64_tr_b16 v[170:171], v50 offset:49664
  ds_read_b64_tr_b16 v[172:173], v51 offset:49152
  ds_read_b64_tr_b16 v[174:175], v51 offset:49664
  s_waitcnt lgkmcnt(14)
  v_mfma_f32_16x16x32_bf16 v[44:47], v[28:31], v[144:147], v[44:47]
  s_waitcnt lgkmcnt(12)
  v_mfma_f32_16x16x32_bf16 v[44:47], v[32:35], v[148:151], v[44:47]
  s_waitcnt lgkmcnt(10)
  v_mfma_f32_16x16x32_bf16 v[44:47], v[36:39], v[152:155], v[44:47]
  s_waitcnt lgkmcnt(8)
  v_mfma_f32_16x16x32_bf16 v[44:47], v[40:43], v[156:159], v[44:47]
  s_waitcnt lgkmcnt(6)
  v_mfma_f32_16x16x32_bf16 v[44:47], v[28:31], v[160:163], v[44:47]
  s_waitcnt lgkmcnt(4)
  v_mfma_f32_16x16x32_bf16 v[44:47], v[32:35], v[164:167], v[44:47]
  s_waitcnt lgkmcnt(2)
  v_mfma_f32_16x16x32_bf16 v[44:47], v[36:39], v[168:171], v[44:47]
  s_waitcnt lgkmcnt(0)
  v_mfma_f32_16x16x32_bf16 v[44:47], v[40:43], v[172:175], v[44:47]
  v_and_b32 v5, 15, v1
  v_lshlrev_b32 v5, 4, v5
  v_bfe_u32 v6, v1, 4, 1
  v_lshl_add_u32 v5, v6, 3, v5
  v_lshrrev_b32 v6, 5, v1
  v_lshl_add_u32 v5, v6, 9, v5
  s_add_u32 s48, s19, 10240
  v_add_u32 v5, s48, v5
  ds_write2_b32 v5, v44, v46 offset0:0 offset1:1
  ds_write2_b32 v5, v45, v47 offset0:64 offset1:65
  v_and_b32 v6, 31, v1
  v_lshlrev_b32 v6, 4, v6
  v_add_u32 v6, 124928, v6
  s_waitcnt lgkmcnt(0)
  s_barrier
  ds_read_b128 v[28:31], v6 offset:0
  ds_read_b128 v[32:35], v6 offset:12288
  ds_read_b128 v[36:39], v6 offset:24576
  ds_read_b128 v[40:43], v6 offset:36864
  s_waitcnt lgkmcnt(2)
  v_pk_add_f32 v[28:29], v[28:29], v[32:33]
  v_pk_add_f32 v[30:31], v[30:31], v[34:35]
  s_waitcnt lgkmcnt(1)
  v_pk_add_f32 v[28:29], v[28:29], v[36:37]
  v_pk_add_f32 v[30:31], v[30:31], v[38:39]
  s_waitcnt lgkmcnt(0)
  v_pk_add_f32 v[28:29], v[28:29], v[40:41]
  v_pk_add_f32 v[30:31], v[30:31], v[42:43]
  s_cmp_lg_u32 s40, 0
  s_cbranch_scc1 L_fin1
  v_mov_b32_sdwa v28, s1 dst_sel:BYTE_0 dst_unused:UNUSED_PRESERVE src0_sel:BYTE_0
  v_mov_b32_sdwa v29, s1 dst_sel:BYTE_0 dst_unused:UNUSED_PRESERVE src0_sel:BYTE_1
  v_mov_b32_sdwa v30, s1 dst_sel:BYTE_0 dst_unused:UNUSED_PRESERVE src0_sel:BYTE_2
  v_mov_b32_sdwa v31, s1 dst_sel:BYTE_0 dst_unused:UNUSED_PRESERVE src0_sel:BYTE_3
  s_lshl_b32 s48, s46, 9
  s_add_u32 s48, s48, 655360
  s_mov_b32 exec_hi, 0
  buffer_store_dwordx4 v[28:31], v2, s[12:15], s48 offen sc1
  s_mov_b32 exec_hi, -1
L_fin1:
  s_waitcnt vmcnt(0) lgkmcnt(0)
  s_branch L_fin
  s_endpgm
.section .rodata,"a"
.p2align 6
.amdhsa_kernel sequential_preLN__linear_attn_block__glu_gated_bilinear__prompt_kernel
  .amdhsa_next_free_vgpr 512
  .amdhsa_next_free_sgpr 102
  .amdhsa_accum_offset 256
  .amdhsa_group_segment_fixed_size 0
  .amdhsa_kernarg_size 80
  .amdhsa_user_sgpr_count 2
  .amdhsa_user_sgpr_kernarg_segment_ptr 1
  .amdhsa_system_sgpr_workgroup_id_x 1
.end_amdhsa_kernel
```
